```python
import torch

def _softmax(x, axis=-1):
    return torch.softmax(x, dim=axis)
def _gelu(x):
    return torch.nn.functional.gelu(x, approximate="tanh")
def _silu(x):
    return torch.nn.functional.silu(x)
def _sigmoid(x):
    return torch.sigmoid(x)
def _layernorm(x, axis=-1, eps=1e-5):
    m = x.mean(dim=axis, keepdim=True)
    v = x.var(dim=axis, keepdim=True, unbiased=False)
    return (x - m) / torch.sqrt(v + eps)
def _scatter_add(tgt, idx, src, axis=0):
    return tgt.clone().index_add_(axis, idx, src)
def _segment_sum(src, seg, n):
    out = torch.zeros((n,) + src.shape[1:], dtype=src.dtype)
    return out.index_add_(0, seg, src)
def _pad(x, pw):
    flat = tuple(v for pair in reversed(pw) for v in pair)
    return torch.nn.functional.pad(x, flat)

kernel_name = 'gated_mix__linear_attn_block__mha_block__prompt'

def setup_inputs():

    _w = (lambda a: (lambda t: t.to(torch.bfloat16) if t.is_floating_point() else t)(torch.as_tensor(a)))
    def _A_setup():
        B, S, D = 1, 2048, 640
        return {
            "x": _w((lambda *s: torch.randn(*s, dtype=torch.bfloat16) * 0.05)(B, S, D)),
            "wqkv": _w((lambda *s: torch.randn(*s, dtype=torch.bfloat16) * 0.8)(D, 3 * D)),
            "wo": _w((lambda *s: torch.randn(*s, dtype=torch.bfloat16) * 0.2)(D, D)),
        }
    _A_in = _A_setup()

    def _B_setup():
        B, S, D, H = 1, 2048, 640, 32
        return {
            "x": _w((lambda *s: torch.randn(*s, dtype=torch.bfloat16) * 0.05)(B, S, D)),
            "wqkv": _w((lambda *s: torch.randn(*s, dtype=torch.bfloat16) * 0.8)(D, 3 * D)),
            "wo": _w((lambda *s: torch.randn(*s, dtype=torch.bfloat16) * 0.05)(D, D)),
        }
    _B_in = _B_setup()

    return {
        "A_x": _A_in["x"],
        "A_wqkv": _A_in["wqkv"],
        "A_wo": _A_in["wo"],
        "B_x": _B_in["x"],
        "B_wqkv": _B_in["wqkv"],
        "B_wo": _B_in["wo"],
        "gate_w": _w((lambda *s: torch.randn(*s, dtype=torch.bfloat16) * 0.05)(640) * 16.0),
    }

def reference(A_x, A_wqkv, A_wo, B_x, B_wqkv, B_wo, gate_w):
    def _A_ref(x, wqkv, wo):
        B, S, D = x.shape
        H = 32; Dh = D // H
        qkv = (lambda x, *d: x.permute(*d))((x @ wqkv).reshape(B, S, 3, H, Dh), 2, 0, 3, 1, 4)
        q, k, v = qkv[0], qkv[1], qkv[2]
        phi = lambda t: torch.where(t > 0, t + 1, torch.exp(t)) + 1e-6
        pq, pk = phi(q), phi(k)
        kv = torch.einsum("bhsd,bhse->bhde", pk, v)
        z = torch.einsum("bhsd->bhd", pk)
        num = torch.einsum("bhqd,bhde->bhqe", pq, kv)
        den = torch.einsum("bhqd,bhd->bhq", pq, z)[..., None] + 1e-6
        o = num / den
        return (lambda x, *d: x.permute(*d))(o, 0, 2, 1, 3).reshape(B, S, D) @ wo

    def _B_ref(x, wqkv, wo):
        B, S, D = x.shape
        H = 32
        Dh = D // H
        qkv = (lambda x, *d: x.permute(*d))((x @ wqkv).reshape(B, S, 3, H, Dh), 2, 0, 3, 1, 4)
        q, k, v = qkv[0], qkv[1], qkv[2]
        scores = torch.einsum("bhqd,bhkd->bhqk", q, k) * (Dh ** -0.5)
        p = _softmax(scores, axis=-1)
        o = torch.einsum("bhqk,bhkd->bhqd", p, v)
        return (lambda x, *d: x.permute(*d))(o, 0, 2, 1, 3).reshape(B, S, D) @ wo

    x = A_x
    g = _sigmoid((x * gate_w).sum(-1, keepdims=True))
    a = _A_ref(x, A_wqkv, A_wo)
    b = _B_ref(x, B_wqkv, B_wo)
    return g * a + (1 - g) * b
```

```asm
; @launch kernel=qkv_kernel grid=(256,1,1) block=(512,1,1) lds=147520
; @launch kernel=attn_kernel grid=(256,1,1) block=(768,1,1) lds=163840
; @launch kernel=oproj_kernel grid=(256,1,1) block=(256,1,1) lds=163840
.amdgcn_target "amdgcn-amd-amdhsa--gfx950"
.text
.globl qkv_kernel
.p2align 8
.type qkv_kernel,@function
qkv_kernel:
    s_cmp_ge_u32 s2, 256
    s_cbranch_scc1 K1_done
    s_load_dwordx16 s[4:19], s[0:1], 0
    s_load_dwordx4 s[20:23], s[0:1], 64
    s_and_b32 s40, s2, 7
    s_lshr_b32 s41, s2, 3
    s_lshr_b32 s46, s40, 2
    s_and_b32 s42, s40, 3
    s_lshl_b32 s42, s42, 1
    s_and_b32 s43, s41, 1
    s_add_u32 s44, s42, s43
    s_lshr_b32 s45, s41, 1
    s_mul_i32 s47, s45, 13
    s_lshr_b32 s47, s47, 6
    s_mul_i32 s42, s47, 5
    s_sub_u32 s42, s45, s42
    s_lshl_b32 s49, s42, 7
    v_lshrrev_b32 v1, 6, v0
    v_and_b32 v0, 63, v0
    s_nop 0
    v_readfirstlane_b32 s48, v1
    s_waitcnt lgkmcnt(0)
    s_mov_b32 s24, s4
    s_and_b32 s25, s5, 0xffff
    s_mov_b32 s26, 2621440
    s_mov_b32 s27, 0x00020000
    s_cmp_eq_u32 s46, 0
    s_cselect_b32 s36, s6, s12
    s_cselect_b32 s37, s7, s13
    s_mov_b32 s28, s36
    s_and_b32 s29, s37, 0xffff
    s_mov_b32 s30, 2457600
    s_mov_b32 s31, 0x00020000
    s_mov_b32 s32, s22
    s_and_b32 s33, s23, 0xffff
    s_mov_b32 s34, 28909568
    s_mov_b32 s35, 0x00020000
    s_cmp_ge_u32 s2, 240
    s_cbranch_scc1 K1_side
    s_cmp_ge_u32 s48, 4
    s_cbranch_scc1 K1_loader
    v_and_b32 v1, 31, v0
    v_lshrrev_b32 v2, 5, v0
    v_bfe_u32 v3, v0, 1, 3
    v_xor_b32 v3, v3, v2
    v_lshlrev_b32 v3, 4, v3
    s_and_b32 s60, s48, 1
    s_lshr_b32 s61, s48, 1
    s_lshl_b32 s50, s60, 7
    v_add_u32 v4, s50, v1
    v_lshlrev_b32 v4, 7, v4
    v_add_u32 v232, v4, v3
    v_xor_b32 v233, 32, v232
    v_xor_b32 v234, 64, v232
    v_xor_b32 v235, 96, v232
    v_bfe_u32 v3, v0, 2, 2
    v_lshl_add_u32 v4, v2, 3, v3
    v_lshlrev_b32 v4, 8, v4
    v_lshl_add_u32 v4, v3, 6, v4
    v_bfe_u32 v5, v0, 4, 1
    v_lshl_add_u32 v4, v5, 5, v4
    v_and_b32 v5, 3, v0
    v_lshl_add_u32 v4, v5, 3, v4
    s_lshl_b32 s50, s61, 7
    v_xor_b32 v4, s50, v4
    v_add_u32 v236, 32768, v4
    v_xor_b32 v4, 64, v4
    v_add_u32 v237, 32768, v4
    v_mov_b32 v8, 0
    v_mov_b32 v9, 0
    v_mov_b32 v10, 0
    v_mov_b32 v11, 0
    v_mov_b32 v12, 0
    v_mov_b32 v13, 0
    v_mov_b32 v14, 0
    v_mov_b32 v15, 0
    v_mov_b32 v16, 0
    v_mov_b32 v17, 0
    v_mov_b32 v18, 0
    v_mov_b32 v19, 0
    v_mov_b32 v20, 0
    v_mov_b32 v21, 0
    v_mov_b32 v22, 0
    v_mov_b32 v23, 0
    v_mov_b32 v24, 0
    v_mov_b32 v25, 0
    v_mov_b32 v26, 0
    v_mov_b32 v27, 0
    v_mov_b32 v28, 0
    v_mov_b32 v29, 0
    v_mov_b32 v30, 0
    v_mov_b32 v31, 0
    v_mov_b32 v32, 0
    v_mov_b32 v33, 0
    v_mov_b32 v34, 0
    v_mov_b32 v35, 0
    v_mov_b32 v36, 0
    v_mov_b32 v37, 0
    v_mov_b32 v38, 0
    v_mov_b32 v39, 0
    v_mov_b32 v40, 0
    v_mov_b32 v41, 0
    v_mov_b32 v42, 0
    v_mov_b32 v43, 0
    v_mov_b32 v44, 0
    v_mov_b32 v45, 0
    v_mov_b32 v46, 0
    v_mov_b32 v47, 0
    v_mov_b32 v48, 0
    v_mov_b32 v49, 0
    v_mov_b32 v50, 0
    v_mov_b32 v51, 0
    v_mov_b32 v52, 0
    v_mov_b32 v53, 0
    v_mov_b32 v54, 0
    v_mov_b32 v55, 0
    v_mov_b32 v56, 0
    v_mov_b32 v57, 0
    v_mov_b32 v58, 0
    v_mov_b32 v59, 0
    v_mov_b32 v60, 0
    v_mov_b32 v61, 0
    v_mov_b32 v62, 0
    v_mov_b32 v63, 0
    v_mov_b32 v64, 0
    v_mov_b32 v65, 0
    v_mov_b32 v66, 0
    v_mov_b32 v67, 0
    v_mov_b32 v68, 0
    v_mov_b32 v69, 0
    v_mov_b32 v70, 0
    v_mov_b32 v71, 0
    v_mov_b32 v72, 0
    v_mov_b32 v73, 0
    v_mov_b32 v74, 0
    v_mov_b32 v75, 0
    v_mov_b32 v76, 0
    v_mov_b32 v77, 0
    v_mov_b32 v78, 0
    v_mov_b32 v79, 0
    v_mov_b32 v80, 0
    v_mov_b32 v81, 0
    v_mov_b32 v82, 0
    v_mov_b32 v83, 0
    v_mov_b32 v84, 0
    v_mov_b32 v85, 0
    v_mov_b32 v86, 0
    v_mov_b32 v87, 0
    v_mov_b32 v88, 0
    v_mov_b32 v89, 0
    v_mov_b32 v90, 0
    v_mov_b32 v91, 0
    v_mov_b32 v92, 0
    v_mov_b32 v93, 0
    v_mov_b32 v94, 0
    v_mov_b32 v95, 0
    v_mov_b32 v96, 0
    v_mov_b32 v97, 0
    v_mov_b32 v98, 0
    v_mov_b32 v99, 0
    v_mov_b32 v100, 0
    v_mov_b32 v101, 0
    v_mov_b32 v102, 0
    v_mov_b32 v103, 0
    v_mov_b32 v104, 0
    v_mov_b32 v105, 0
    v_mov_b32 v106, 0
    v_mov_b32 v107, 0
    v_mov_b32 v108, 0
    v_mov_b32 v109, 0
    v_mov_b32 v110, 0
    v_mov_b32 v111, 0
    v_mov_b32 v112, 0
    v_mov_b32 v113, 0
    v_mov_b32 v114, 0
    v_mov_b32 v115, 0
    v_mov_b32 v116, 0
    v_mov_b32 v117, 0
    v_mov_b32 v118, 0
    v_mov_b32 v119, 0
    v_mov_b32 v120, 0
    v_mov_b32 v121, 0
    v_mov_b32 v122, 0
    v_mov_b32 v123, 0
    v_mov_b32 v124, 0
    v_mov_b32 v125, 0
    v_mov_b32 v126, 0
    v_mov_b32 v127, 0
    v_mov_b32 v128, 0
    v_mov_b32 v129, 0
    v_mov_b32 v130, 0
    v_mov_b32 v131, 0
    v_mov_b32 v132, 0
    v_mov_b32 v133, 0
    v_mov_b32 v134, 0
    v_mov_b32 v135, 0
    s_mov_b32 s50, 0
    v_mov_b32 v238, 147456
    v_mov_b32 v242, 147472
    v_mov_b32 v239, 1
    v_mov_b32 v240, 0
    v_mov_b32 v241, 0
    s_mov_b32 s66, 0
    s_cmp_lg_u32 s48, 0
    s_cbranch_scc1 K1_noinit
    ds_write_b64 v238, v[240:241]
    ds_write_b64 v238, v[240:241] offset:8
    ds_write_b64 v238, v[240:241] offset:16
    ds_write_b64 v238, v[240:241] offset:24
    s_waitcnt lgkmcnt(0)
K1_noinit:
    s_barrier
    s_mov_b32 s63, 1
K1_sp0:
    ds_read_b64 v[240:241], v238
    s_waitcnt lgkmcnt(0)
    v_min_u32 v240, v240, v241
    s_nop 0
    v_readfirstlane_b32 s62, v240
    s_nop 3
    s_cmp_ge_u32 s62, s63
    s_cbranch_scc1 K1_sp0_ok
    s_sleep 1
    s_branch K1_sp0
K1_sp0_ok:
    v_xor_b32 v238, 8, v238
    s_cmp_eq_u32 s47, 2
    s_cbranch_scc1 K1_loopN
    s_cmp_eq_u32 s47, 1
    s_cselect_b32 s51, s46, 1
    s_cmp_eq_u32 s51, 0
    s_cbranch_scc1 K1_loopN
    ds_read_b64_tr_b16 v[200:201], v236 offset:0
    ds_read_b64_tr_b16 v[202:203], v236 offset:1024
    ds_read_b64_tr_b16 v[204:205], v237 offset:0
    ds_read_b64_tr_b16 v[206:207], v237 offset:1024
    ds_read_b128 v[136:139], v232 offset:0
    ds_read_b128 v[140:143], v232 offset:4096
    ds_read_b128 v[144:147], v232 offset:8192
    ds_read_b128 v[148:151], v232 offset:12288
    v_add_u32 v232, 49152, v232
    ds_read_b64_tr_b16 v[208:209], v236 offset:4096
    ds_read_b64_tr_b16 v[210:211], v236 offset:5120
    ds_read_b64_tr_b16 v[212:213], v237 offset:4096
    ds_read_b64_tr_b16 v[214:215], v237 offset:5120
    ds_read_b128 v[152:155], v233 offset:0
    ds_read_b128 v[156:159], v233 offset:4096
    ds_read_b128 v[160:163], v233 offset:8192
    ds_read_b128 v[164:167], v233 offset:12288
    v_add_u32 v233, 49152, v233
    s_mov_b32 s53, 10
    s_mov_b32 s63, 1
    s_mov_b32 s64, 1
K1_loopT_l:
    s_waitcnt lgkmcnt(8)
    v_mfma_f32_32x32x16_bf16 v[8:23], v[200:203], v[136:139], v[8:23]
    s_add_u32 s55, s50, 49152
    s_cmp_eq_u32 s55, 147456
    s_cselect_b32 s55, 0, s55
    s_sub_u32 s51, s55, s50
    ds_read_b64_tr_b16 v[216:217], v236 offset:8192
    v_mfma_f32_32x32x16_bf16 v[40:55], v[200:203], v[140:143], v[40:55]
    s_add_u32 s56, s55, 49152
    s_cmp_eq_u32 s56, 147456
    s_cselect_b32 s56, 0, s56
    s_sub_u32 s52, s56, s55
    s_mov_b32 s50, s55
    ds_read_b64_tr_b16 v[218:219], v236 offset:9216
    v_mfma_f32_32x32x16_bf16 v[72:87], v[200:203], v[144:147], v[72:87]
    ds_read_b64_tr_b16 v[220:221], v237 offset:8192
    v_mfma_f32_32x32x16_bf16 v[104:119], v[200:203], v[148:151], v[104:119]
    ds_read_b64_tr_b16 v[222:223], v237 offset:9216
    v_mfma_f32_32x32x16_bf16 v[24:39], v[204:207], v[136:139], v[24:39]
    ds_read_b128 v[168:171], v234 offset:0
    v_mfma_f32_32x32x16_bf16 v[56:71], v[204:207], v[140:143], v[56:71]
    ds_read_b128 v[172:175], v234 offset:4096
    v_mfma_f32_32x32x16_bf16 v[88:103], v[204:207], v[144:147], v[88:103]
    ds_read_b128 v[176:179], v234 offset:8192
    v_mfma_f32_32x32x16_bf16 v[120:135], v[204:207], v[148:151], v[120:135]
    ds_read_b128 v[180:183], v234 offset:12288
    v_add_u32 v234, s51, v234
    s_waitcnt lgkmcnt(8)
    v_mfma_f32_32x32x16_bf16 v[8:23], v[208:211], v[152:155], v[8:23]
    ds_read_b64 v[240:241], v238
    ds_read_b64_tr_b16 v[224:225], v236 offset:12288
    v_mfma_f32_32x32x16_bf16 v[40:55], v[208:211], v[156:159], v[40:55]
    ds_read_b64_tr_b16 v[226:227], v236 offset:13312
    ds_read_b64_tr_b16 v[228:229], v237 offset:12288
    v_mfma_f32_32x32x16_bf16 v[72:87], v[208:211], v[160:163], v[72:87]
    ds_read_b64_tr_b16 v[230:231], v237 offset:13312
    ds_read_b128 v[184:187], v235 offset:0
    v_mfma_f32_32x32x16_bf16 v[104:119], v[208:211], v[164:167], v[104:119]
    ds_read_b128 v[188:191], v235 offset:4096
    ds_read_b128 v[192:195], v235 offset:8192
    v_mfma_f32_32x32x16_bf16 v[24:39], v[212:215], v[152:155], v[24:39]
    ds_read_b128 v[196:199], v235 offset:12288
    v_mfma_f32_32x32x16_bf16 v[56:71], v[212:215], v[156:159], v[56:71]
    v_mfma_f32_32x32x16_bf16 v[88:103], v[212:215], v[160:163], v[88:103]
    v_mfma_f32_32x32x16_bf16 v[120:135], v[212:215], v[164:167], v[120:135]
    v_add_u32 v235, s51, v235
    s_waitcnt lgkmcnt(0)
    v_mfma_f32_32x32x16_bf16 v[8:23], v[216:219], v[168:171], v[8:23]
    v_add_u32 v243, s66, v242
    v_min_u32 v240, v240, v241
    s_mov_b64 exec, 1
    ds_add_u32 v243, v239
    s_mov_b64 exec, -1
    v_mfma_f32_32x32x16_bf16 v[40:55], v[216:219], v[172:175], v[40:55]
    v_readfirstlane_b32 s62, v240
    v_add_u32 v236, s51, v236
    v_add_u32 v237, s51, v237
    s_add_u32 s66, s66, 4
    s_cmp_eq_u32 s66, 12
    s_cselect_b32 s66, 0, s66
    v_mfma_f32_32x32x16_bf16 v[72:87], v[216:219], v[176:179], v[72:87]
    s_cmp_ge_u32 s62, s63
    s_cbranch_scc1 K1_loopT_l_rdy
K1_loopT_l_sp:
    ds_read_b64 v[240:241], v238
    s_waitcnt lgkmcnt(0)
    v_min_u32 v240, v240, v241
    s_nop 0
    v_readfirstlane_b32 s62, v240
    s_nop 3
    s_cmp_ge_u32 s62, s63
    s_cbranch_scc1 K1_loopT_l_sp_ok
    s_sleep 1
    s_branch K1_loopT_l_sp
K1_loopT_l_sp_ok:
K1_loopT_l_rdy:
    v_xor_b32 v238, 8, v238
    s_add_u32 s64, s64, 1
    s_lshr_b32 s63, s64, 1
    s_add_u32 s63, s63, 1
    s_cmp_ge_u32 s64, 10
    s_cselect_b32 s63, 0, s63
    v_mfma_f32_32x32x16_bf16 v[104:119], v[216:219], v[180:183], v[104:119]
    ds_read_b64_tr_b16 v[200:201], v236 offset:0
    ds_read_b64_tr_b16 v[202:203], v236 offset:1024
    v_mfma_f32_32x32x16_bf16 v[24:39], v[220:223], v[168:171], v[24:39]
    ds_read_b64_tr_b16 v[204:205], v237 offset:0
    ds_read_b64_tr_b16 v[206:207], v237 offset:1024
    v_mfma_f32_32x32x16_bf16 v[56:71], v[220:223], v[172:175], v[56:71]
    ds_read_b128 v[136:139], v232 offset:0
    ds_read_b128 v[140:143], v232 offset:4096
    v_mfma_f32_32x32x16_bf16 v[88:103], v[220:223], v[176:179], v[88:103]
    ds_read_b128 v[144:147], v232 offset:8192
    ds_read_b128 v[148:151], v232 offset:12288
    v_mfma_f32_32x32x16_bf16 v[120:135], v[220:223], v[180:183], v[120:135]
    v_add_u32 v232, s52, v232
    s_waitcnt lgkmcnt(8)
    v_mfma_f32_32x32x16_bf16 v[8:23], v[224:227], v[184:187], v[8:23]
    ds_read_b64_tr_b16 v[208:209], v236 offset:4096
    v_mfma_f32_32x32x16_bf16 v[40:55], v[224:227], v[188:191], v[40:55]
    ds_read_b64_tr_b16 v[210:211], v236 offset:5120
    v_mfma_f32_32x32x16_bf16 v[72:87], v[224:227], v[192:195], v[72:87]
    ds_read_b64_tr_b16 v[212:213], v237 offset:4096
    v_mfma_f32_32x32x16_bf16 v[104:119], v[224:227], v[196:199], v[104:119]
    ds_read_b64_tr_b16 v[214:215], v237 offset:5120
    v_mfma_f32_32x32x16_bf16 v[24:39], v[228:231], v[184:187], v[24:39]
    ds_read_b128 v[152:155], v233 offset:0
    v_mfma_f32_32x32x16_bf16 v[56:71], v[228:231], v[188:191], v[56:71]
    ds_read_b128 v[156:159], v233 offset:4096
    v_mfma_f32_32x32x16_bf16 v[88:103], v[228:231], v[192:195], v[88:103]
    ds_read_b128 v[160:163], v233 offset:8192
    v_mfma_f32_32x32x16_bf16 v[120:135], v[228:231], v[196:199], v[120:135]
    ds_read_b128 v[164:167], v233 offset:12288
    v_add_u32 v233, s52, v233
    s_sub_u32 s53, s53, 1
    s_cmp_lg_u32 s53, 0
    s_cbranch_scc1 K1_loopT_l
    s_waitcnt lgkmcnt(0)
    v_and_b32 v1, 31, v0
    v_lshrrev_b32 v2, 5, v0
    s_lshl_b32 s53, s44, 8
    s_lshl_b32 s54, s60, 7
    s_add_u32 s53, s53, s54
    s_lshl_b32 s54, s61, 6
    s_add_u32 s49, s49, s54
    s_nop 7
    s_nop 7
    s_lshr_b32 s54, s49, 2
    v_add_u32 v3, s54, v2
    s_cmp_eq_u32 s47, 1
    s_cbranch_scc1 K1_epiK
    s_mul_i32 s55, s53, 40
    s_cmp_eq_u32 s46, 0
    s_cbranch_scc1 K1_epiPQ
    s_mov_b32 s58, 1051011932
    s_mov_b32 s59, 1051011932
    v_add_u32 v4, 0, v3
    v_mul_u32_u24 v5, 205, v4
    v_lshrrev_b32 v5, 10, v5
    v_mul_u32_u24 v6, 5, v5
    v_sub_u32 v6, v4, v6
    v_mul_u32_u24 v5, 0x14000, v5
    v_lshl_add_u32 v5, v6, 8, v5
    v_lshl_add_u32 v136, v1, 3, v5
    v_add_u32 v4, 2, v3
    v_mul_u32_u24 v5, 205, v4
    v_lshrrev_b32 v5, 10, v5
    v_mul_u32_u24 v6, 5, v5
    v_sub_u32 v6, v4, v6
    v_mul_u32_u24 v5, 0x14000, v5
    v_lshl_add_u32 v5, v6, 8, v5
    v_lshl_add_u32 v137, v1, 3, v5
    v_add_u32 v4, 4, v3
    v_mul_u32_u24 v5, 205, v4
    v_lshrrev_b32 v5, 10, v5
    v_mul_u32_u24 v6, 5, v5
    v_sub_u32 v6, v4, v6
    v_mul_u32_u24 v5, 0x14000, v5
    v_lshl_add_u32 v5, v6, 8, v5
    v_lshl_add_u32 v138, v1, 3, v5
    v_add_u32 v4, 6, v3
    v_mul_u32_u24 v5, 205, v4
    v_lshrrev_b32 v5, 10, v5
    v_mul_u32_u24 v6, 5, v5
    v_sub_u32 v6, v4, v6
    v_mul_u32_u24 v5, 0x14000, v5
    v_lshl_add_u32 v5, v6, 8, v5
    v_lshl_add_u32 v139, v1, 3, v5
    v_add_u32 v4, 8, v3
    v_mul_u32_u24 v5, 205, v4
    v_lshrrev_b32 v5, 10, v5
    v_mul_u32_u24 v6, 5, v5
    v_sub_u32 v6, v4, v6
    v_mul_u32_u24 v5, 0x14000, v5
    v_lshl_add_u32 v5, v6, 8, v5
    v_lshl_add_u32 v140, v1, 3, v5
    v_add_u32 v4, 10, v3
    v_mul_u32_u24 v5, 205, v4
    v_lshrrev_b32 v5, 10, v5
    v_mul_u32_u24 v6, 5, v5
    v_sub_u32 v6, v4, v6
    v_mul_u32_u24 v5, 0x14000, v5
    v_lshl_add_u32 v5, v6, 8, v5
    v_lshl_add_u32 v141, v1, 3, v5
    v_add_u32 v4, 12, v3
    v_mul_u32_u24 v5, 205, v4
    v_lshrrev_b32 v5, 10, v5
    v_mul_u32_u24 v6, 5, v5
    v_sub_u32 v6, v4, v6
    v_mul_u32_u24 v5, 0x14000, v5
    v_lshl_add_u32 v5, v6, 8, v5
    v_lshl_add_u32 v142, v1, 3, v5
    v_add_u32 v4, 14, v3
    v_mul_u32_u24 v5, 205, v4
    v_lshrrev_b32 v5, 10, v5
    v_mul_u32_u24 v6, 5, v5
    v_sub_u32 v6, v4, v6
    v_mul_u32_u24 v5, 0x14000, v5
    v_lshl_add_u32 v5, v6, 8, v5
    v_lshl_add_u32 v143, v1, 3, v5
    s_add_u32 s56, s55, 0
    v_pk_mul_f32 v[8:9], v[8:9], s[58:59]
    v_pk_mul_f32 v[10:11], v[10:11], s[58:59]
    v_pk_mul_f32 v[12:13], v[12:13], s[58:59]
    v_pk_mul_f32 v[14:15], v[14:15], s[58:59]
    v_pk_mul_f32 v[16:17], v[16:17], s[58:59]
    v_pk_mul_f32 v[18:19], v[18:19], s[58:59]
    v_pk_mul_f32 v[20:21], v[20:21], s[58:59]
    v_pk_mul_f32 v[22:23], v[22:23], s[58:59]
    v_cvt_pk_bf16_f32 v8, v8, v9
    v_cvt_pk_bf16_f32 v9, v10, v11
    v_cvt_pk_bf16_f32 v12, v12, v13
    v_cvt_pk_bf16_f32 v13, v14, v15
    v_cvt_pk_bf16_f32 v16, v16, v17
    v_cvt_pk_bf16_f32 v17, v18, v19
    v_cvt_pk_bf16_f32 v20, v20, v21
    v_cvt_pk_bf16_f32 v21, v22, v23
    buffer_store_dwordx2 v[8:9], v136, s[32:35], s56 offen
    buffer_store_dwordx2 v[12:13], v137, s[32:35], s56 offen
    buffer_store_dwordx2 v[16:17], v138, s[32:35], s56 offen
    buffer_store_dwordx2 v[20:21], v139, s[32:35], s56 offen
    v_pk_mul_f32 v[24:25], v[24:25], s[58:59]
    v_pk_mul_f32 v[26:27], v[26:27], s[58:59]
    v_pk_mul_f32 v[28:29], v[28:29], s[58:59]
    v_pk_mul_f32 v[30:31], v[30:31], s[58:59]
    v_pk_mul_f32 v[32:33], v[32:33], s[58:59]
    v_pk_mul_f32 v[34:35], v[34:35], s[58:59]
    v_pk_mul_f32 v[36:37], v[36:37], s[58:59]
    v_pk_mul_f32 v[38:39], v[38:39], s[58:59]
    v_cvt_pk_bf16_f32 v24, v24, v25
    v_cvt_pk_bf16_f32 v25, v26, v27
    v_cvt_pk_bf16_f32 v28, v28, v29
    v_cvt_pk_bf16_f32 v29, v30, v31
    v_cvt_pk_bf16_f32 v32, v32, v33
    v_cvt_pk_bf16_f32 v33, v34, v35
    v_cvt_pk_bf16_f32 v36, v36, v37
    v_cvt_pk_bf16_f32 v37, v38, v39
    buffer_store_dwordx2 v[24:25], v140, s[32:35], s56 offen
    buffer_store_dwordx2 v[28:29], v141, s[32:35], s56 offen
    buffer_store_dwordx2 v[32:33], v142, s[32:35], s56 offen
    buffer_store_dwordx2 v[36:37], v143, s[32:35], s56 offen
    s_add_u32 s56, s55, 1280
    v_pk_mul_f32 v[40:41], v[40:41], s[58:59]
    v_pk_mul_f32 v[42:43], v[42:43], s[58:59]
    v_pk_mul_f32 v[44:45], v[44:45], s[58:59]
    v_pk_mul_f32 v[46:47], v[46:47], s[58:59]
    v_pk_mul_f32 v[48:49], v[48:49], s[58:59]
    v_pk_mul_f32 v[50:51], v[50:51], s[58:59]
    v_pk_mul_f32 v[52:53], v[52:53], s[58:59]
    v_pk_mul_f32 v[54:55], v[54:55], s[58:59]
    v_cvt_pk_bf16_f32 v40, v40, v41
    v_cvt_pk_bf16_f32 v41, v42, v43
    v_cvt_pk_bf16_f32 v44, v44, v45
    v_cvt_pk_bf16_f32 v45, v46, v47
    v_cvt_pk_bf16_f32 v48, v48, v49
    v_cvt_pk_bf16_f32 v49, v50, v51
    v_cvt_pk_bf16_f32 v52, v52, v53
    v_cvt_pk_bf16_f32 v53, v54, v55
    buffer_store_dwordx2 v[40:41], v136, s[32:35], s56 offen
    buffer_store_dwordx2 v[44:45], v137, s[32:35], s56 offen
    buffer_store_dwordx2 v[48:49], v138, s[32:35], s56 offen
    buffer_store_dwordx2 v[52:53], v139, s[32:35], s56 offen
    v_pk_mul_f32 v[56:57], v[56:57], s[58:59]
    v_pk_mul_f32 v[58:59], v[58:59], s[58:59]
    v_pk_mul_f32 v[60:61], v[60:61], s[58:59]
    v_pk_mul_f32 v[62:63], v[62:63], s[58:59]
    v_pk_mul_f32 v[64:65], v[64:65], s[58:59]
    v_pk_mul_f32 v[66:67], v[66:67], s[58:59]
    v_pk_mul_f32 v[68:69], v[68:69], s[58:59]
    v_pk_mul_f32 v[70:71], v[70:71], s[58:59]
    v_cvt_pk_bf16_f32 v56, v56, v57
    v_cvt_pk_bf16_f32 v57, v58, v59
    v_cvt_pk_bf16_f32 v60, v60, v61
    v_cvt_pk_bf16_f32 v61, v62, v63
    v_cvt_pk_bf16_f32 v64, v64, v65
    v_cvt_pk_bf16_f32 v65, v66, v67
    v_cvt_pk_bf16_f32 v68, v68, v69
    v_cvt_pk_bf16_f32 v69, v70, v71
    buffer_store_dwordx2 v[56:57], v140, s[32:35], s56 offen
    buffer_store_dwordx2 v[60:61], v141, s[32:35], s56 offen
    buffer_store_dwordx2 v[64:65], v142, s[32:35], s56 offen
    buffer_store_dwordx2 v[68:69], v143, s[32:35], s56 offen
    s_add_u32 s56, s55, 2560
    v_pk_mul_f32 v[72:73], v[72:73], s[58:59]
    v_pk_mul_f32 v[74:75], v[74:75], s[58:59]
    v_pk_mul_f32 v[76:77], v[76:77], s[58:59]
    v_pk_mul_f32 v[78:79], v[78:79], s[58:59]
    v_pk_mul_f32 v[80:81], v[80:81], s[58:59]
    v_pk_mul_f32 v[82:83], v[82:83], s[58:59]
    v_pk_mul_f32 v[84:85], v[84:85], s[58:59]
    v_pk_mul_f32 v[86:87], v[86:87], s[58:59]
    v_cvt_pk_bf16_f32 v72, v72, v73
    v_cvt_pk_bf16_f32 v73, v74, v75
    v_cvt_pk_bf16_f32 v76, v76, v77
    v_cvt_pk_bf16_f32 v77, v78, v79
    v_cvt_pk_bf16_f32 v80, v80, v81
    v_cvt_pk_bf16_f32 v81, v82, v83
    v_cvt_pk_bf16_f32 v84, v84, v85
    v_cvt_pk_bf16_f32 v85, v86, v87
    buffer_store_dwordx2 v[72:73], v136, s[32:35], s56 offen
    buffer_store_dwordx2 v[76:77], v137, s[32:35], s56 offen
    buffer_store_dwordx2 v[80:81], v138, s[32:35], s56 offen
    buffer_store_dwordx2 v[84:85], v139, s[32:35], s56 offen
    v_pk_mul_f32 v[88:89], v[88:89], s[58:59]
    v_pk_mul_f32 v[90:91], v[90:91], s[58:59]
    v_pk_mul_f32 v[92:93], v[92:93], s[58:59]
    v_pk_mul_f32 v[94:95], v[94:95], s[58:59]
    v_pk_mul_f32 v[96:97], v[96:97], s[58:59]
    v_pk_mul_f32 v[98:99], v[98:99], s[58:59]
    v_pk_mul_f32 v[100:101], v[100:101], s[58:59]
    v_pk_mul_f32 v[102:103], v[102:103], s[58:59]
    v_cvt_pk_bf16_f32 v88, v88, v89
    v_cvt_pk_bf16_f32 v89, v90, v91
    v_cvt_pk_bf16_f32 v92, v92, v93
    v_cvt_pk_bf16_f32 v93, v94, v95
    v_cvt_pk_bf16_f32 v96, v96, v97
    v_cvt_pk_bf16_f32 v97, v98, v99
    v_cvt_pk_bf16_f32 v100, v100, v101
    v_cvt_pk_bf16_f32 v101, v102, v103
    buffer_store_dwordx2 v[88:89], v140, s[32:35], s56 offen
    buffer_store_dwordx2 v[92:93], v141, s[32:35], s56 offen
    buffer_store_dwordx2 v[96:97], v142, s[32:35], s56 offen
    buffer_store_dwordx2 v[100:101], v143, s[32:35], s56 offen
    s_add_u32 s56, s55, 3840
    v_pk_mul_f32 v[104:105], v[104:105], s[58:59]
    v_pk_mul_f32 v[106:107], v[106:107], s[58:59]
    v_pk_mul_f32 v[108:109], v[108:109], s[58:59]
    v_pk_mul_f32 v[110:111], v[110:111], s[58:59]
    v_pk_mul_f32 v[112:113], v[112:113], s[58:59]
    v_pk_mul_f32 v[114:115], v[114:115], s[58:59]
    v_pk_mul_f32 v[116:117], v[116:117], s[58:59]
    v_pk_mul_f32 v[118:119], v[118:119], s[58:59]
    v_cvt_pk_bf16_f32 v104, v104, v105
    v_cvt_pk_bf16_f32 v105, v106, v107
    v_cvt_pk_bf16_f32 v108, v108, v109
    v_cvt_pk_bf16_f32 v109, v110, v111
    v_cvt_pk_bf16_f32 v112, v112, v113
    v_cvt_pk_bf16_f32 v113, v114, v115
    v_cvt_pk_bf16_f32 v116, v116, v117
    v_cvt_pk_bf16_f32 v117, v118, v119
    buffer_store_dwordx2 v[104:105], v136, s[32:35], s56 offen
    buffer_store_dwordx2 v[108:109], v137, s[32:35], s56 offen
    buffer_store_dwordx2 v[112:113], v138, s[32:35], s56 offen
    buffer_store_dwordx2 v[116:117], v139, s[32:35], s56 offen
    v_pk_mul_f32 v[120:121], v[120:121], s[58:59]
    v_pk_mul_f32 v[122:123], v[122:123], s[58:59]
    v_pk_mul_f32 v[124:125], v[124:125], s[58:59]
    v_pk_mul_f32 v[126:127], v[126:127], s[58:59]
    v_pk_mul_f32 v[128:129], v[128:129], s[58:59]
    v_pk_mul_f32 v[130:131], v[130:131], s[58:59]
    v_pk_mul_f32 v[132:133], v[132:133], s[58:59]
    v_pk_mul_f32 v[134:135], v[134:135], s[58:59]
    v_cvt_pk_bf16_f32 v120, v120, v121
    v_cvt_pk_bf16_f32 v121, v122, v123
    v_cvt_pk_bf16_f32 v124, v124, v125
    v_cvt_pk_bf16_f32 v125, v126, v127
    v_cvt_pk_bf16_f32 v128, v128, v129
    v_cvt_pk_bf16_f32 v129, v130, v131
    v_cvt_pk_bf16_f32 v132, v132, v133
    v_cvt_pk_bf16_f32 v133, v134, v135
    buffer_store_dwordx2 v[120:121], v140, s[32:35], s56 offen
    buffer_store_dwordx2 v[124:125], v141, s[32:35], s56 offen
    buffer_store_dwordx2 v[128:129], v142, s[32:35], s56 offen
    buffer_store_dwordx2 v[132:133], v143, s[32:35], s56 offen
    s_endpgm
K1_epiPQ:
    s_mov_b32 s58, 1069066811
    s_mov_b32 s59, 1069066811
    s_mov_b32 s60, 897988541
    s_mov_b32 s61, 897988541
    v_add_u32 v4, 0, v3
    v_mul_u32_u24 v5, 205, v4
    v_lshrrev_b32 v5, 10, v5
    v_mul_u32_u24 v6, 5, v5
    v_sub_u32 v6, v4, v6
    v_mul_u32_u24 v5, 0x14000, v5
    v_lshl_add_u32 v5, v6, 8, v5
    v_lshl_add_u32 v136, v1, 3, v5
    v_add_u32 v4, 2, v3
    v_mul_u32_u24 v5, 205, v4
    v_lshrrev_b32 v5, 10, v5
    v_mul_u32_u24 v6, 5, v5
    v_sub_u32 v6, v4, v6
    v_mul_u32_u24 v5, 0x14000, v5
    v_lshl_add_u32 v5, v6, 8, v5
    v_lshl_add_u32 v137, v1, 3, v5
    v_add_u32 v4, 4, v3
    v_mul_u32_u24 v5, 205, v4
    v_lshrrev_b32 v5, 10, v5
    v_mul_u32_u24 v6, 5, v5
    v_sub_u32 v6, v4, v6
    v_mul_u32_u24 v5, 0x14000, v5
    v_lshl_add_u32 v5, v6, 8, v5
    v_lshl_add_u32 v138, v1, 3, v5
    v_add_u32 v4, 6, v3
    v_mul_u32_u24 v5, 205, v4
    v_lshrrev_b32 v5, 10, v5
    v_mul_u32_u24 v6, 5, v5
    v_sub_u32 v6, v4, v6
    v_mul_u32_u24 v5, 0x14000, v5
    v_lshl_add_u32 v5, v6, 8, v5
    v_lshl_add_u32 v139, v1, 3, v5
    v_add_u32 v4, 8, v3
    v_mul_u32_u24 v5, 205, v4
    v_lshrrev_b32 v5, 10, v5
    v_mul_u32_u24 v6, 5, v5
    v_sub_u32 v6, v4, v6
    v_mul_u32_u24 v5, 0x14000, v5
    v_lshl_add_u32 v5, v6, 8, v5
    v_lshl_add_u32 v140, v1, 3, v5
    v_add_u32 v4, 10, v3
    v_mul_u32_u24 v5, 205, v4
    v_lshrrev_b32 v5, 10, v5
    v_mul_u32_u24 v6, 5, v5
    v_sub_u32 v6, v4, v6
    v_mul_u32_u24 v5, 0x14000, v5
    v_lshl_add_u32 v5, v6, 8, v5
    v_lshl_add_u32 v141, v1, 3, v5
    v_add_u32 v4, 12, v3
    v_mul_u32_u24 v5, 205, v4
    v_lshrrev_b32 v5, 10, v5
    v_mul_u32_u24 v6, 5, v5
    v_sub_u32 v6, v4, v6
    v_mul_u32_u24 v5, 0x14000, v5
    v_lshl_add_u32 v5, v6, 8, v5
    v_lshl_add_u32 v142, v1, 3, v5
    v_add_u32 v4, 14, v3
    v_mul_u32_u24 v5, 205, v4
    v_lshrrev_b32 v5, 10, v5
    v_mul_u32_u24 v6, 5, v5
    v_sub_u32 v6, v4, v6
    v_mul_u32_u24 v5, 0x14000, v5
    v_lshl_add_u32 v5, v6, 8, v5
    v_lshl_add_u32 v143, v1, 3, v5
    s_add_u32 s56, s55, 7864320
    v_pk_mul_f32 v[144:145], v[8:9], s[58:59]
    v_pk_mul_f32 v[146:147], v[10:11], s[58:59]
    v_pk_mul_f32 v[148:149], v[12:13], s[58:59]
    v_pk_mul_f32 v[150:151], v[14:15], s[58:59]
    v_pk_mul_f32 v[152:153], v[16:17], s[58:59]
    v_pk_mul_f32 v[154:155], v[18:19], s[58:59]
    v_pk_mul_f32 v[156:157], v[20:21], s[58:59]
    v_pk_mul_f32 v[158:159], v[22:23], s[58:59]
    v_min_f32 v144, 0, v144
    v_min_f32 v145, 0, v145
    v_min_f32 v146, 0, v146
    v_min_f32 v147, 0, v147
    v_min_f32 v148, 0, v148
    v_min_f32 v149, 0, v149
    v_min_f32 v150, 0, v150
    v_min_f32 v151, 0, v151
    v_min_f32 v152, 0, v152
    v_min_f32 v153, 0, v153
    v_min_f32 v154, 0, v154
    v_min_f32 v155, 0, v155
    v_min_f32 v156, 0, v156
    v_min_f32 v157, 0, v157
    v_min_f32 v158, 0, v158
    v_min_f32 v159, 0, v159
    v_exp_f32 v144, v144
    v_exp_f32 v145, v145
    v_exp_f32 v146, v146
    v_exp_f32 v147, v147
    v_exp_f32 v148, v148
    v_exp_f32 v149, v149
    v_exp_f32 v150, v150
    v_exp_f32 v151, v151
    v_exp_f32 v152, v152
    v_exp_f32 v153, v153
    v_exp_f32 v154, v154
    v_exp_f32 v155, v155
    v_exp_f32 v156, v156
    v_exp_f32 v157, v157
    v_exp_f32 v158, v158
    v_exp_f32 v159, v159
    v_pk_add_f32 v[8:9], v[8:9], s[60:61]
    v_pk_add_f32 v[10:11], v[10:11], s[60:61]
    v_pk_add_f32 v[12:13], v[12:13], s[60:61]
    v_pk_add_f32 v[14:15], v[14:15], s[60:61]
    v_pk_add_f32 v[16:17], v[16:17], s[60:61]
    v_pk_add_f32 v[18:19], v[18:19], s[60:61]
    v_pk_add_f32 v[20:21], v[20:21], s[60:61]
    v_pk_add_f32 v[22:23], v[22:23], s[60:61]
    v_max_f32 v8, s60, v8
    v_max_f32 v9, s60, v9
    v_max_f32 v10, s60, v10
    v_max_f32 v11, s60, v11
    v_max_f32 v12, s60, v12
    v_max_f32 v13, s60, v13
    v_max_f32 v14, s60, v14
    v_max_f32 v15, s60, v15
    v_max_f32 v16, s60, v16
    v_max_f32 v17, s60, v17
    v_max_f32 v18, s60, v18
    v_max_f32 v19, s60, v19
    v_max_f32 v20, s60, v20
    v_max_f32 v21, s60, v21
    v_max_f32 v22, s60, v22
    v_max_f32 v23, s60, v23
    v_pk_add_f32 v[8:9], v[8:9], v[144:145]
    v_pk_add_f32 v[10:11], v[10:11], v[146:147]
    v_pk_add_f32 v[12:13], v[12:13], v[148:149]
    v_pk_add_f32 v[14:15], v[14:15], v[150:151]
    v_pk_add_f32 v[16:17], v[16:17], v[152:153]
    v_pk_add_f32 v[18:19], v[18:19], v[154:155]
    v_pk_add_f32 v[20:21], v[20:21], v[156:157]
    v_pk_add_f32 v[22:23], v[22:23], v[158:159]
    v_cvt_pk_bf16_f32 v8, v8, v9
    v_cvt_pk_bf16_f32 v9, v10, v11
    v_cvt_pk_bf16_f32 v12, v12, v13
    v_cvt_pk_bf16_f32 v13, v14, v15
    v_cvt_pk_bf16_f32 v16, v16, v17
    v_cvt_pk_bf16_f32 v17, v18, v19
    v_cvt_pk_bf16_f32 v20, v20, v21
    v_cvt_pk_bf16_f32 v21, v22, v23
    buffer_store_dwordx2 v[8:9], v136, s[32:35], s56 offen
    buffer_store_dwordx2 v[12:13], v137, s[32:35], s56 offen
    buffer_store_dwordx2 v[16:17], v138, s[32:35], s56 offen
    buffer_store_dwordx2 v[20:21], v139, s[32:35], s56 offen
    v_pk_mul_f32 v[144:145], v[24:25], s[58:59]
    v_pk_mul_f32 v[146:147], v[26:27], s[58:59]
    v_pk_mul_f32 v[148:149], v[28:29], s[58:59]
    v_pk_mul_f32 v[150:151], v[30:31], s[58:59]
    v_pk_mul_f32 v[152:153], v[32:33], s[58:59]
    v_pk_mul_f32 v[154:155], v[34:35], s[58:59]
    v_pk_mul_f32 v[156:157], v[36:37], s[58:59]
    v_pk_mul_f32 v[158:159], v[38:39], s[58:59]
    v_min_f32 v144, 0, v144
    v_min_f32 v145, 0, v145
    v_min_f32 v146, 0, v146
    v_min_f32 v147, 0, v147
    v_min_f32 v148, 0, v148
    v_min_f32 v149, 0, v149
    v_min_f32 v150, 0, v150
    v_min_f32 v151, 0, v151
    v_min_f32 v152, 0, v152
    v_min_f32 v153, 0, v153
    v_min_f32 v154, 0, v154
    v_min_f32 v155, 0, v155
    v_min_f32 v156, 0, v156
    v_min_f32 v157, 0, v157
    v_min_f32 v158, 0, v158
    v_min_f32 v159, 0, v159
    v_exp_f32 v144, v144
    v_exp_f32 v145, v145
    v_exp_f32 v146, v146
    v_exp_f32 v147, v147
    v_exp_f32 v148, v148
    v_exp_f32 v149, v149
    v_exp_f32 v150, v150
    v_exp_f32 v151, v151
    v_exp_f32 v152, v152
    v_exp_f32 v153, v153
    v_exp_f32 v154, v154
    v_exp_f32 v155, v155
    v_exp_f32 v156, v156
    v_exp_f32 v157, v157
    v_exp_f32 v158, v158
    v_exp_f32 v159, v159
    v_pk_add_f32 v[24:25], v[24:25], s[60:61]
    v_pk_add_f32 v[26:27], v[26:27], s[60:61]
    v_pk_add_f32 v[28:29], v[28:29], s[60:61]
    v_pk_add_f32 v[30:31], v[30:31], s[60:61]
    v_pk_add_f32 v[32:33], v[32:33], s[60:61]
    v_pk_add_f32 v[34:35], v[34:35], s[60:61]
    v_pk_add_f32 v[36:37], v[36:37], s[60:61]
    v_pk_add_f32 v[38:39], v[38:39], s[60:61]
    v_max_f32 v24, s60, v24
    v_max_f32 v25, s60, v25
    v_max_f32 v26, s60, v26
    v_max_f32 v27, s60, v27
    v_max_f32 v28, s60, v28
    v_max_f32 v29, s60, v29
    v_max_f32 v30, s60, v30
    v_max_f32 v31, s60, v31
    v_max_f32 v32, s60, v32
    v_max_f32 v33, s60, v33
    v_max_f32 v34, s60, v34
    v_max_f32 v35, s60, v35
    v_max_f32 v36, s60, v36
    v_max_f32 v37, s60, v37
    v_max_f32 v38, s60, v38
    v_max_f32 v39, s60, v39
    v_pk_add_f32 v[24:25], v[24:25], v[144:145]
    v_pk_add_f32 v[26:27], v[26:27], v[146:147]
    v_pk_add_f32 v[28:29], v[28:29], v[148:149]
    v_pk_add_f32 v[30:31], v[30:31], v[150:151]
    v_pk_add_f32 v[32:33], v[32:33], v[152:153]
    v_pk_add_f32 v[34:35], v[34:35], v[154:155]
    v_pk_add_f32 v[36:37], v[36:37], v[156:157]
    v_pk_add_f32 v[38:39], v[38:39], v[158:159]
    v_cvt_pk_bf16_f32 v24, v24, v25
    v_cvt_pk_bf16_f32 v25, v26, v27
    v_cvt_pk_bf16_f32 v28, v28, v29
    v_cvt_pk_bf16_f32 v29, v30, v31
    v_cvt_pk_bf16_f32 v32, v32, v33
    v_cvt_pk_bf16_f32 v33, v34, v35
    v_cvt_pk_bf16_f32 v36, v36, v37
    v_cvt_pk_bf16_f32 v37, v38, v39
    buffer_store_dwordx2 v[24:25], v140, s[32:35], s56 offen
    buffer_store_dwordx2 v[28:29], v141, s[32:35], s56 offen
    buffer_store_dwordx2 v[32:33], v142, s[32:35], s56 offen
    buffer_store_dwordx2 v[36:37], v143, s[32:35], s56 offen
    s_add_u32 s56, s55, 7865600
    v_pk_mul_f32 v[144:145], v[40:41], s[58:59]
    v_pk_mul_f32 v[146:147], v[42:43], s[58:59]
    v_pk_mul_f32 v[148:149], v[44:45], s[58:59]
    v_pk_mul_f32 v[150:151], v[46:47], s[58:59]
    v_pk_mul_f32 v[152:153], v[48:49], s[58:59]
    v_pk_mul_f32 v[154:155], v[50:51], s[58:59]
    v_pk_mul_f32 v[156:157], v[52:53], s[58:59]
    v_pk_mul_f32 v[158:159], v[54:55], s[58:59]
    v_min_f32 v144, 0, v144
    v_min_f32 v145, 0, v145
    v_min_f32 v146, 0, v146
    v_min_f32 v147, 0, v147
    v_min_f32 v148, 0, v148
    v_min_f32 v149, 0, v149
    v_min_f32 v150, 0, v150
    v_min_f32 v151, 0, v151
    v_min_f32 v152, 0, v152
    v_min_f32 v153, 0, v153
    v_min_f32 v154, 0, v154
    v_min_f32 v155, 0, v155
    v_min_f32 v156, 0, v156
    v_min_f32 v157, 0, v157
    v_min_f32 v158, 0, v158
    v_min_f32 v159, 0, v159
    v_exp_f32 v144, v144
    v_exp_f32 v145, v145
    v_exp_f32 v146, v146
    v_exp_f32 v147, v147
    v_exp_f32 v148, v148
    v_exp_f32 v149, v149
    v_exp_f32 v150, v150
    v_exp_f32 v151, v151
    v_exp_f32 v152, v152
    v_exp_f32 v153, v153
    v_exp_f32 v154, v154
    v_exp_f32 v155, v155
    v_exp_f32 v156, v156
    v_exp_f32 v157, v157
    v_exp_f32 v158, v158
    v_exp_f32 v159, v159
    v_pk_add_f32 v[40:41], v[40:41], s[60:61]
    v_pk_add_f32 v[42:43], v[42:43], s[60:61]
    v_pk_add_f32 v[44:45], v[44:45], s[60:61]
    v_pk_add_f32 v[46:47], v[46:47], s[60:61]
    v_pk_add_f32 v[48:49], v[48:49], s[60:61]
    v_pk_add_f32 v[50:51], v[50:51], s[60:61]
    v_pk_add_f32 v[52:53], v[52:53], s[60:61]
    v_pk_add_f32 v[54:55], v[54:55], s[60:61]
    v_max_f32 v40, s60, v40
    v_max_f32 v41, s60, v41
    v_max_f32 v42, s60, v42
    v_max_f32 v43, s60, v43
    v_max_f32 v44, s60, v44
    v_max_f32 v45, s60, v45
    v_max_f32 v46, s60, v46
    v_max_f32 v47, s60, v47
    v_max_f32 v48, s60, v48
    v_max_f32 v49, s60, v49
    v_max_f32 v50, s60, v50
    v_max_f32 v51, s60, v51
    v_max_f32 v52, s60, v52
    v_max_f32 v53, s60, v53
    v_max_f32 v54, s60, v54
    v_max_f32 v55, s60, v55
    v_pk_add_f32 v[40:41], v[40:41], v[144:145]
    v_pk_add_f32 v[42:43], v[42:43], v[146:147]
    v_pk_add_f32 v[44:45], v[44:45], v[148:149]
    v_pk_add_f32 v[46:47], v[46:47], v[150:151]
    v_pk_add_f32 v[48:49], v[48:49], v[152:153]
    v_pk_add_f32 v[50:51], v[50:51], v[154:155]
    v_pk_add_f32 v[52:53], v[52:53], v[156:157]
    v_pk_add_f32 v[54:55], v[54:55], v[158:159]
    v_cvt_pk_bf16_f32 v40, v40, v41
    v_cvt_pk_bf16_f32 v41, v42, v43
    v_cvt_pk_bf16_f32 v44, v44, v45
    v_cvt_pk_bf16_f32 v45, v46, v47
    v_cvt_pk_bf16_f32 v48, v48, v49
    v_cvt_pk_bf16_f32 v49, v50, v51
    v_cvt_pk_bf16_f32 v52, v52, v53
    v_cvt_pk_bf16_f32 v53, v54, v55
    buffer_store_dwordx2 v[40:41], v136, s[32:35], s56 offen
    buffer_store_dwordx2 v[44:45], v137, s[32:35], s56 offen
    buffer_store_dwordx2 v[48:49], v138, s[32:35], s56 offen
    buffer_store_dwordx2 v[52:53], v139, s[32:35], s56 offen
    v_pk_mul_f32 v[144:145], v[56:57], s[58:59]
    v_pk_mul_f32 v[146:147], v[58:59], s[58:59]
    v_pk_mul_f32 v[148:149], v[60:61], s[58:59]
    v_pk_mul_f32 v[150:151], v[62:63], s[58:59]
    v_pk_mul_f32 v[152:153], v[64:65], s[58:59]
    v_pk_mul_f32 v[154:155], v[66:67], s[58:59]
    v_pk_mul_f32 v[156:157], v[68:69], s[58:59]
    v_pk_mul_f32 v[158:159], v[70:71], s[58:59]
    v_min_f32 v144, 0, v144
    v_min_f32 v145, 0, v145
    v_min_f32 v146, 0, v146
    v_min_f32 v147, 0, v147
    v_min_f32 v148, 0, v148
    v_min_f32 v149, 0, v149
    v_min_f32 v150, 0, v150
    v_min_f32 v151, 0, v151
    v_min_f32 v152, 0, v152
    v_min_f32 v153, 0, v153
    v_min_f32 v154, 0, v154
    v_min_f32 v155, 0, v155
    v_min_f32 v156, 0, v156
    v_min_f32 v157, 0, v157
    v_min_f32 v158, 0, v158
    v_min_f32 v159, 0, v159
    v_exp_f32 v144, v144
    v_exp_f32 v145, v145
    v_exp_f32 v146, v146
    v_exp_f32 v147, v147
    v_exp_f32 v148, v148
    v_exp_f32 v149, v149
    v_exp_f32 v150, v150
    v_exp_f32 v151, v151
    v_exp_f32 v152, v152
    v_exp_f32 v153, v153
    v_exp_f32 v154, v154
    v_exp_f32 v155, v155
    v_exp_f32 v156, v156
    v_exp_f32 v157, v157
    v_exp_f32 v158, v158
    v_exp_f32 v159, v159
    v_pk_add_f32 v[56:57], v[56:57], s[60:61]
    v_pk_add_f32 v[58:59], v[58:59], s[60:61]
    v_pk_add_f32 v[60:61], v[60:61], s[60:61]
    v_pk_add_f32 v[62:63], v[62:63], s[60:61]
    v_pk_add_f32 v[64:65], v[64:65], s[60:61]
    v_pk_add_f32 v[66:67], v[66:67], s[60:61]
    v_pk_add_f32 v[68:69], v[68:69], s[60:61]
    v_pk_add_f32 v[70:71], v[70:71], s[60:61]
    v_max_f32 v56, s60, v56
    v_max_f32 v57, s60, v57
    v_max_f32 v58, s60, v58
    v_max_f32 v59, s60, v59
    v_max_f32 v60, s60, v60
    v_max_f32 v61, s60, v61
    v_max_f32 v62, s60, v62
    v_max_f32 v63, s60, v63
    v_max_f32 v64, s60, v64
    v_max_f32 v65, s60, v65
    v_max_f32 v66, s60, v66
    v_max_f32 v67, s60, v67
    v_max_f32 v68, s60, v68
    v_max_f32 v69, s60, v69
    v_max_f32 v70, s60, v70
    v_max_f32 v71, s60, v71
    v_pk_add_f32 v[56:57], v[56:57], v[144:145]
    v_pk_add_f32 v[58:59], v[58:59], v[146:147]
    v_pk_add_f32 v[60:61], v[60:61], v[148:149]
    v_pk_add_f32 v[62:63], v[62:63], v[150:151]
    v_pk_add_f32 v[64:65], v[64:65], v[152:153]
    v_pk_add_f32 v[66:67], v[66:67], v[154:155]
    v_pk_add_f32 v[68:69], v[68:69], v[156:157]
    v_pk_add_f32 v[70:71], v[70:71], v[158:159]
    v_cvt_pk_bf16_f32 v56, v56, v57
    v_cvt_pk_bf16_f32 v57, v58, v59
    v_cvt_pk_bf16_f32 v60, v60, v61
    v_cvt_pk_bf16_f32 v61, v62, v63
    v_cvt_pk_bf16_f32 v64, v64, v65
    v_cvt_pk_bf16_f32 v65, v66, v67
    v_cvt_pk_bf16_f32 v68, v68, v69
    v_cvt_pk_bf16_f32 v69, v70, v71
    buffer_store_dwordx2 v[56:57], v140, s[32:35], s56 offen
    buffer_store_dwordx2 v[60:61], v141, s[32:35], s56 offen
    buffer_store_dwordx2 v[64:65], v142, s[32:35], s56 offen
    buffer_store_dwordx2 v[68:69], v143, s[32:35], s56 offen
    s_add_u32 s56, s55, 7866880
    v_pk_mul_f32 v[144:145], v[72:73], s[58:59]
    v_pk_mul_f32 v[146:147], v[74:75], s[58:59]
    v_pk_mul_f32 v[148:149], v[76:77], s[58:59]
    v_pk_mul_f32 v[150:151], v[78:79], s[58:59]
    v_pk_mul_f32 v[152:153], v[80:81], s[58:59]
    v_pk_mul_f32 v[154:155], v[82:83], s[58:59]
    v_pk_mul_f32 v[156:157], v[84:85], s[58:59]
    v_pk_mul_f32 v[158:159], v[86:87], s[58:59]
    v_min_f32 v144, 0, v144
    v_min_f32 v145, 0, v145
    v_min_f32 v146, 0, v146
    v_min_f32 v147, 0, v147
    v_min_f32 v148, 0, v148
    v_min_f32 v149, 0, v149
    v_min_f32 v150, 0, v150
    v_min_f32 v151, 0, v151
    v_min_f32 v152, 0, v152
    v_min_f32 v153, 0, v153
    v_min_f32 v154, 0, v154
    v_min_f32 v155, 0, v155
    v_min_f32 v156, 0, v156
    v_min_f32 v157, 0, v157
    v_min_f32 v158, 0, v158
    v_min_f32 v159, 0, v159
    v_exp_f32 v144, v144
    v_exp_f32 v145, v145
    v_exp_f32 v146, v146
    v_exp_f32 v147, v147
    v_exp_f32 v148, v148
    v_exp_f32 v149, v149
    v_exp_f32 v150, v150
    v_exp_f32 v151, v151
    v_exp_f32 v152, v152
    v_exp_f32 v153, v153
    v_exp_f32 v154, v154
    v_exp_f32 v155, v155
    v_exp_f32 v156, v156
    v_exp_f32 v157, v157
    v_exp_f32 v158, v158
    v_exp_f32 v159, v159
    v_pk_add_f32 v[72:73], v[72:73], s[60:61]
    v_pk_add_f32 v[74:75], v[74:75], s[60:61]
    v_pk_add_f32 v[76:77], v[76:77], s[60:61]
    v_pk_add_f32 v[78:79], v[78:79], s[60:61]
    v_pk_add_f32 v[80:81], v[80:81], s[60:61]
    v_pk_add_f32 v[82:83], v[82:83], s[60:61]
    v_pk_add_f32 v[84:85], v[84:85], s[60:61]
    v_pk_add_f32 v[86:87], v[86:87], s[60:61]
    v_max_f32 v72, s60, v72
    v_max_f32 v73, s60, v73
    v_max_f32 v74, s60, v74
    v_max_f32 v75, s60, v75
    v_max_f32 v76, s60, v76
    v_max_f32 v77, s60, v77
    v_max_f32 v78, s60, v78
    v_max_f32 v79, s60, v79
    v_max_f32 v80, s60, v80
    v_max_f32 v81, s60, v81
    v_max_f32 v82, s60, v82
    v_max_f32 v83, s60, v83
    v_max_f32 v84, s60, v84
    v_max_f32 v85, s60, v85
    v_max_f32 v86, s60, v86
    v_max_f32 v87, s60, v87
    v_pk_add_f32 v[72:73], v[72:73], v[144:145]
    v_pk_add_f32 v[74:75], v[74:75], v[146:147]
    v_pk_add_f32 v[76:77], v[76:77], v[148:149]
    v_pk_add_f32 v[78:79], v[78:79], v[150:151]
    v_pk_add_f32 v[80:81], v[80:81], v[152:153]
    v_pk_add_f32 v[82:83], v[82:83], v[154:155]
    v_pk_add_f32 v[84:85], v[84:85], v[156:157]
    v_pk_add_f32 v[86:87], v[86:87], v[158:159]
    v_cvt_pk_bf16_f32 v72, v72, v73
    v_cvt_pk_bf16_f32 v73, v74, v75
    v_cvt_pk_bf16_f32 v76, v76, v77
    v_cvt_pk_bf16_f32 v77, v78, v79
    v_cvt_pk_bf16_f32 v80, v80, v81
    v_cvt_pk_bf16_f32 v81, v82, v83
    v_cvt_pk_bf16_f32 v84, v84, v85
    v_cvt_pk_bf16_f32 v85, v86, v87
    buffer_store_dwordx2 v[72:73], v136, s[32:35], s56 offen
    buffer_store_dwordx2 v[76:77], v137, s[32:35], s56 offen
    buffer_store_dwordx2 v[80:81], v138, s[32:35], s56 offen
    buffer_store_dwordx2 v[84:85], v139, s[32:35], s56 offen
    v_pk_mul_f32 v[144:145], v[88:89], s[58:59]
    v_pk_mul_f32 v[146:147], v[90:91], s[58:59]
    v_pk_mul_f32 v[148:149], v[92:93], s[58:59]
    v_pk_mul_f32 v[150:151], v[94:95], s[58:59]
    v_pk_mul_f32 v[152:153], v[96:97], s[58:59]
    v_pk_mul_f32 v[154:155], v[98:99], s[58:59]
    v_pk_mul_f32 v[156:157], v[100:101], s[58:59]
    v_pk_mul_f32 v[158:159], v[102:103], s[58:59]
    v_min_f32 v144, 0, v144
    v_min_f32 v145, 0, v145
    v_min_f32 v146, 0, v146
    v_min_f32 v147, 0, v147
    v_min_f32 v148, 0, v148
    v_min_f32 v149, 0, v149
    v_min_f32 v150, 0, v150
    v_min_f32 v151, 0, v151
    v_min_f32 v152, 0, v152
    v_min_f32 v153, 0, v153
    v_min_f32 v154, 0, v154
    v_min_f32 v155, 0, v155
    v_min_f32 v156, 0, v156
    v_min_f32 v157, 0, v157
    v_min_f32 v158, 0, v158
    v_min_f32 v159, 0, v159
    v_exp_f32 v144, v144
    v_exp_f32 v145, v145
    v_exp_f32 v146, v146
    v_exp_f32 v147, v147
    v_exp_f32 v148, v148
    v_exp_f32 v149, v149
    v_exp_f32 v150, v150
    v_exp_f32 v151, v151
    v_exp_f32 v152, v152
    v_exp_f32 v153, v153
    v_exp_f32 v154, v154
    v_exp_f32 v155, v155
    v_exp_f32 v156, v156
    v_exp_f32 v157, v157
    v_exp_f32 v158, v158
    v_exp_f32 v159, v159
    v_pk_add_f32 v[88:89], v[88:89], s[60:61]
    v_pk_add_f32 v[90:91], v[90:91], s[60:61]
    v_pk_add_f32 v[92:93], v[92:93], s[60:61]
    v_pk_add_f32 v[94:95], v[94:95], s[60:61]
    v_pk_add_f32 v[96:97], v[96:97], s[60:61]
    v_pk_add_f32 v[98:99], v[98:99], s[60:61]
    v_pk_add_f32 v[100:101], v[100:101], s[60:61]
    v_pk_add_f32 v[102:103], v[102:103], s[60:61]
    v_max_f32 v88, s60, v88
    v_max_f32 v89, s60, v89
    v_max_f32 v90, s60, v90
    v_max_f32 v91, s60, v91
    v_max_f32 v92, s60, v92
    v_max_f32 v93, s60, v93
    v_max_f32 v94, s60, v94
    v_max_f32 v95, s60, v95
    v_max_f32 v96, s60, v96
    v_max_f32 v97, s60, v97
    v_max_f32 v98, s60, v98
    v_max_f32 v99, s60, v99
    v_max_f32 v100, s60, v100
    v_max_f32 v101, s60, v101
    v_max_f32 v102, s60, v102
    v_max_f32 v103, s60, v103
    v_pk_add_f32 v[88:89], v[88:89], v[144:145]
    v_pk_add_f32 v[90:91], v[90:91], v[146:147]
    v_pk_add_f32 v[92:93], v[92:93], v[148:149]
    v_pk_add_f32 v[94:95], v[94:95], v[150:151]
    v_pk_add_f32 v[96:97], v[96:97], v[152:153]
    v_pk_add_f32 v[98:99], v[98:99], v[154:155]
    v_pk_add_f32 v[100:101], v[100:101], v[156:157]
    v_pk_add_f32 v[102:103], v[102:103], v[158:159]
    v_cvt_pk_bf16_f32 v88, v88, v89
    v_cvt_pk_bf16_f32 v89, v90, v91
    v_cvt_pk_bf16_f32 v92, v92, v93
    v_cvt_pk_bf16_f32 v93, v94, v95
    v_cvt_pk_bf16_f32 v96, v96, v97
    v_cvt_pk_bf16_f32 v97, v98, v99
    v_cvt_pk_bf16_f32 v100, v100, v101
    v_cvt_pk_bf16_f32 v101, v102, v103
    buffer_store_dwordx2 v[88:89], v140, s[32:35], s56 offen
    buffer_store_dwordx2 v[92:93], v141, s[32:35], s56 offen
    buffer_store_dwordx2 v[96:97], v142, s[32:35], s56 offen
    buffer_store_dwordx2 v[100:101], v143, s[32:35], s56 offen
    s_add_u32 s56, s55, 7868160
    v_pk_mul_f32 v[144:145], v[104:105], s[58:59]
    v_pk_mul_f32 v[146:147], v[106:107], s[58:59]
    v_pk_mul_f32 v[148:149], v[108:109], s[58:59]
    v_pk_mul_f32 v[150:151], v[110:111], s[58:59]
    v_pk_mul_f32 v[152:153], v[112:113], s[58:59]
    v_pk_mul_f32 v[154:155], v[114:115], s[58:59]
    v_pk_mul_f32 v[156:157], v[116:117], s[58:59]
    v_pk_mul_f32 v[158:159], v[118:119], s[58:59]
    v_min_f32 v144, 0, v144
    v_min_f32 v145, 0, v145
    v_min_f32 v146, 0, v146
    v_min_f32 v147, 0, v147
    v_min_f32 v148, 0, v148
    v_min_f32 v149, 0, v149
    v_min_f32 v150, 0, v150
    v_min_f32 v151, 0, v151
    v_min_f32 v152, 0, v152
    v_min_f32 v153, 0, v153
    v_min_f32 v154, 0, v154
    v_min_f32 v155, 0, v155
    v_min_f32 v156, 0, v156
    v_min_f32 v157, 0, v157
    v_min_f32 v158, 0, v158
    v_min_f32 v159, 0, v159
    v_exp_f32 v144, v144
    v_exp_f32 v145, v145
    v_exp_f32 v146, v146
    v_exp_f32 v147, v147
    v_exp_f32 v148, v148
    v_exp_f32 v149, v149
    v_exp_f32 v150, v150
    v_exp_f32 v151, v151
    v_exp_f32 v152, v152
    v_exp_f32 v153, v153
    v_exp_f32 v154, v154
    v_exp_f32 v155, v155
    v_exp_f32 v156, v156
    v_exp_f32 v157, v157
    v_exp_f32 v158, v158
    v_exp_f32 v159, v159
    v_pk_add_f32 v[104:105], v[104:105], s[60:61]
    v_pk_add_f32 v[106:107], v[106:107], s[60:61]
    v_pk_add_f32 v[108:109], v[108:109], s[60:61]
    v_pk_add_f32 v[110:111], v[110:111], s[60:61]
    v_pk_add_f32 v[112:113], v[112:113], s[60:61]
    v_pk_add_f32 v[114:115], v[114:115], s[60:61]
    v_pk_add_f32 v[116:117], v[116:117], s[60:61]
    v_pk_add_f32 v[118:119], v[118:119], s[60:61]
    v_max_f32 v104, s60, v104
    v_max_f32 v105, s60, v105
    v_max_f32 v106, s60, v106
    v_max_f32 v107, s60, v107
    v_max_f32 v108, s60, v108
    v_max_f32 v109, s60, v109
    v_max_f32 v110, s60, v110
    v_max_f32 v111, s60, v111
    v_max_f32 v112, s60, v112
    v_max_f32 v113, s60, v113
    v_max_f32 v114, s60, v114
    v_max_f32 v115, s60, v115
    v_max_f32 v116, s60, v116
    v_max_f32 v117, s60, v117
    v_max_f32 v118, s60, v118
    v_max_f32 v119, s60, v119
    v_pk_add_f32 v[104:105], v[104:105], v[144:145]
    v_pk_add_f32 v[106:107], v[106:107], v[146:147]
    v_pk_add_f32 v[108:109], v[108:109], v[148:149]
    v_pk_add_f32 v[110:111], v[110:111], v[150:151]
    v_pk_add_f32 v[112:113], v[112:113], v[152:153]
    v_pk_add_f32 v[114:115], v[114:115], v[154:155]
    v_pk_add_f32 v[116:117], v[116:117], v[156:157]
    v_pk_add_f32 v[118:119], v[118:119], v[158:159]
    v_cvt_pk_bf16_f32 v104, v104, v105
    v_cvt_pk_bf16_f32 v105, v106, v107
    v_cvt_pk_bf16_f32 v108, v108, v109
    v_cvt_pk_bf16_f32 v109, v110, v111
    v_cvt_pk_bf16_f32 v112, v112, v113
    v_cvt_pk_bf16_f32 v113, v114, v115
    v_cvt_pk_bf16_f32 v116, v116, v117
    v_cvt_pk_bf16_f32 v117, v118, v119
    buffer_store_dwordx2 v[104:105], v136, s[32:35], s56 offen
    buffer_store_dwordx2 v[108:109], v137, s[32:35], s56 offen
    buffer_store_dwordx2 v[112:113], v138, s[32:35], s56 offen
    buffer_store_dwordx2 v[116:117], v139, s[32:35], s56 offen
    v_pk_mul_f32 v[144:145], v[120:121], s[58:59]
    v_pk_mul_f32 v[146:147], v[122:123], s[58:59]
    v_pk_mul_f32 v[148:149], v[124:125], s[58:59]
    v_pk_mul_f32 v[150:151], v[126:127], s[58:59]
    v_pk_mul_f32 v[152:153], v[128:129], s[58:59]
    v_pk_mul_f32 v[154:155], v[130:131], s[58:59]
    v_pk_mul_f32 v[156:157], v[132:133], s[58:59]
    v_pk_mul_f32 v[158:159], v[134:135], s[58:59]
    v_min_f32 v144, 0, v144
    v_min_f32 v145, 0, v145
    v_min_f32 v146, 0, v146
    v_min_f32 v147, 0, v147
    v_min_f32 v148, 0, v148
    v_min_f32 v149, 0, v149
    v_min_f32 v150, 0, v150
    v_min_f32 v151, 0, v151
    v_min_f32 v152, 0, v152
    v_min_f32 v153, 0, v153
    v_min_f32 v154, 0, v154
    v_min_f32 v155, 0, v155
    v_min_f32 v156, 0, v156
    v_min_f32 v157, 0, v157
    v_min_f32 v158, 0, v158
    v_min_f32 v159, 0, v159
    v_exp_f32 v144, v144
    v_exp_f32 v145, v145
    v_exp_f32 v146, v146
    v_exp_f32 v147, v147
    v_exp_f32 v148, v148
    v_exp_f32 v149, v149
    v_exp_f32 v150, v150
    v_exp_f32 v151, v151
    v_exp_f32 v152, v152
    v_exp_f32 v153, v153
    v_exp_f32 v154, v154
    v_exp_f32 v155, v155
    v_exp_f32 v156, v156
    v_exp_f32 v157, v157
    v_exp_f32 v158, v158
    v_exp_f32 v159, v159
    v_pk_add_f32 v[120:121], v[120:121], s[60:61]
    v_pk_add_f32 v[122:123], v[122:123], s[60:61]
    v_pk_add_f32 v[124:125], v[124:125], s[60:61]
    v_pk_add_f32 v[126:127], v[126:127], s[60:61]
    v_pk_add_f32 v[128:129], v[128:129], s[60:61]
    v_pk_add_f32 v[130:131], v[130:131], s[60:61]
    v_pk_add_f32 v[132:133], v[132:133], s[60:61]
    v_pk_add_f32 v[134:135], v[134:135], s[60:61]
    v_max_f32 v120, s60, v120
    v_max_f32 v121, s60, v121
    v_max_f32 v122, s60, v122
    v_max_f32 v123, s60, v123
    v_max_f32 v124, s60, v124
    v_max_f32 v125, s60, v125
    v_max_f32 v126, s60, v126
    v_max_f32 v127, s60, v127
    v_max_f32 v128, s60, v128
    v_max_f32 v129, s60, v129
    v_max_f32 v130, s60, v130
    v_max_f32 v131, s60, v131
    v_max_f32 v132, s60, v132
    v_max_f32 v133, s60, v133
    v_max_f32 v134, s60, v134
    v_max_f32 v135, s60, v135
    v_pk_add_f32 v[120:121], v[120:121], v[144:145]
    v_pk_add_f32 v[122:123], v[122:123], v[146:147]
    v_pk_add_f32 v[124:125], v[124:125], v[148:149]
    v_pk_add_f32 v[126:127], v[126:127], v[150:151]
    v_pk_add_f32 v[128:129], v[128:129], v[152:153]
    v_pk_add_f32 v[130:131], v[130:131], v[154:155]
    v_pk_add_f32 v[132:133], v[132:133], v[156:157]
    v_pk_add_f32 v[134:135], v[134:135], v[158:159]
    v_cvt_pk_bf16_f32 v120, v120, v121
    v_cvt_pk_bf16_f32 v121, v122, v123
    v_cvt_pk_bf16_f32 v124, v124, v125
    v_cvt_pk_bf16_f32 v125, v126, v127
    v_cvt_pk_bf16_f32 v128, v128, v129
    v_cvt_pk_bf16_f32 v129, v130, v131
    v_cvt_pk_bf16_f32 v132, v132, v133
    v_cvt_pk_bf16_f32 v133, v134, v135
    buffer_store_dwordx2 v[120:121], v140, s[32:35], s56 offen
    buffer_store_dwordx2 v[124:125], v141, s[32:35], s56 offen
    buffer_store_dwordx2 v[128:129], v142, s[32:35], s56 offen
    buffer_store_dwordx2 v[132:133], v143, s[32:35], s56 offen
    s_endpgm
K1_epiK:
    s_lshr_b32 s55, s53, 5
    s_mul_i32 s55, s55, 2560
    s_add_u32 s55, s55, 2621440
    s_mov_b32 s57, 163840
    v_add_u32 v4, 0, v3
    v_mul_u32_u24 v5, 205, v4
    v_lshrrev_b32 v5, 10, v5
    v_mul_u32_u24 v6, 5, v5
    v_sub_u32 v6, v4, v6
    v_mul_lo_u32 v5, s57, v5
    v_lshrrev_b32 v7, 1, v6
    v_lshl_add_u32 v5, v7, 9, v5
    v_and_b32 v7, 1, v6
    v_lshl_add_u32 v5, v7, 3, v5
    v_cmp_gt_u32 vcc, 4, v6
    v_mov_b32 v6, 3
    v_mov_b32 v7, 4
    v_cndmask_b32 v6, v6, v7, vcc
    v_lshlrev_b32 v7, v6, v1
    v_add_u32 v136, v5, v7
    v_add_u32 v4, 2, v3
    v_mul_u32_u24 v5, 205, v4
    v_lshrrev_b32 v5, 10, v5
    v_mul_u32_u24 v6, 5, v5
    v_sub_u32 v6, v4, v6
    v_mul_lo_u32 v5, s57, v5
    v_lshrrev_b32 v7, 1, v6
    v_lshl_add_u32 v5, v7, 9, v5
    v_and_b32 v7, 1, v6
    v_lshl_add_u32 v5, v7, 3, v5
    v_cmp_gt_u32 vcc, 4, v6
    v_mov_b32 v6, 3
    v_mov_b32 v7, 4
    v_cndmask_b32 v6, v6, v7, vcc
    v_lshlrev_b32 v7, v6, v1
    v_add_u32 v137, v5, v7
    v_add_u32 v4, 4, v3
    v_mul_u32_u24 v5, 205, v4
    v_lshrrev_b32 v5, 10, v5
    v_mul_u32_u24 v6, 5, v5
    v_sub_u32 v6, v4, v6
    v_mul_lo_u32 v5, s57, v5
    v_lshrrev_b32 v7, 1, v6
    v_lshl_add_u32 v5, v7, 9, v5
    v_and_b32 v7, 1, v6
    v_lshl_add_u32 v5, v7, 3, v5
    v_cmp_gt_u32 vcc, 4, v6
    v_mov_b32 v6, 3
    v_mov_b32 v7, 4
    v_cndmask_b32 v6, v6, v7, vcc
    v_lshlrev_b32 v7, v6, v1
    v_add_u32 v138, v5, v7
    v_add_u32 v4, 6, v3
    v_mul_u32_u24 v5, 205, v4
    v_lshrrev_b32 v5, 10, v5
    v_mul_u32_u24 v6, 5, v5
    v_sub_u32 v6, v4, v6
    v_mul_lo_u32 v5, s57, v5
    v_lshrrev_b32 v7, 1, v6
    v_lshl_add_u32 v5, v7, 9, v5
    v_and_b32 v7, 1, v6
    v_lshl_add_u32 v5, v7, 3, v5
    v_cmp_gt_u32 vcc, 4, v6
    v_mov_b32 v6, 3
    v_mov_b32 v7, 4
    v_cndmask_b32 v6, v6, v7, vcc
    v_lshlrev_b32 v7, v6, v1
    v_add_u32 v139, v5, v7
    v_add_u32 v4, 8, v3
    v_mul_u32_u24 v5, 205, v4
    v_lshrrev_b32 v5, 10, v5
    v_mul_u32_u24 v6, 5, v5
    v_sub_u32 v6, v4, v6
    v_mul_lo_u32 v5, s57, v5
    v_lshrrev_b32 v7, 1, v6
    v_lshl_add_u32 v5, v7, 9, v5
    v_and_b32 v7, 1, v6
    v_lshl_add_u32 v5, v7, 3, v5
    v_cmp_gt_u32 vcc, 4, v6
    v_mov_b32 v6, 3
    v_mov_b32 v7, 4
    v_cndmask_b32 v6, v6, v7, vcc
    v_lshlrev_b32 v7, v6, v1
    v_add_u32 v140, v5, v7
    v_add_u32 v4, 10, v3
    v_mul_u32_u24 v5, 205, v4
    v_lshrrev_b32 v5, 10, v5
    v_mul_u32_u24 v6, 5, v5
    v_sub_u32 v6, v4, v6
    v_mul_lo_u32 v5, s57, v5
    v_lshrrev_b32 v7, 1, v6
    v_lshl_add_u32 v5, v7, 9, v5
    v_and_b32 v7, 1, v6
    v_lshl_add_u32 v5, v7, 3, v5
    v_cmp_gt_u32 vcc, 4, v6
    v_mov_b32 v6, 3
    v_mov_b32 v7, 4
    v_cndmask_b32 v6, v6, v7, vcc
    v_lshlrev_b32 v7, v6, v1
    v_add_u32 v141, v5, v7
    v_add_u32 v4, 12, v3
    v_mul_u32_u24 v5, 205, v4
    v_lshrrev_b32 v5, 10, v5
    v_mul_u32_u24 v6, 5, v5
    v_sub_u32 v6, v4, v6
    v_mul_lo_u32 v5, s57, v5
    v_lshrrev_b32 v7, 1, v6
    v_lshl_add_u32 v5, v7, 9, v5
    v_and_b32 v7, 1, v6
    v_lshl_add_u32 v5, v7, 3, v5
    v_cmp_gt_u32 vcc, 4, v6
    v_mov_b32 v6, 3
    v_mov_b32 v7, 4
    v_cndmask_b32 v6, v6, v7, vcc
    v_lshlrev_b32 v7, v6, v1
    v_add_u32 v142, v5, v7
    v_add_u32 v4, 14, v3
    v_mul_u32_u24 v5, 205, v4
    v_lshrrev_b32 v5, 10, v5
    v_mul_u32_u24 v6, 5, v5
    v_sub_u32 v6, v4, v6
    v_mul_lo_u32 v5, s57, v5
    v_lshrrev_b32 v7, 1, v6
    v_lshl_add_u32 v5, v7, 9, v5
    v_and_b32 v7, 1, v6
    v_lshl_add_u32 v5, v7, 3, v5
    v_cmp_gt_u32 vcc, 4, v6
    v_mov_b32 v6, 3
    v_mov_b32 v7, 4
    v_cndmask_b32 v6, v6, v7, vcc
    v_lshlrev_b32 v7, v6, v1
    v_add_u32 v143, v5, v7
    s_add_u32 s56, s55, 0
    v_cvt_pk_bf16_f32 v8, v8, v9
    v_cvt_pk_bf16_f32 v9, v10, v11
    v_cvt_pk_bf16_f32 v12, v12, v13
    v_cvt_pk_bf16_f32 v13, v14, v15
    v_cvt_pk_bf16_f32 v16, v16, v17
    v_cvt_pk_bf16_f32 v17, v18, v19
    v_cvt_pk_bf16_f32 v20, v20, v21
    v_cvt_pk_bf16_f32 v21, v22, v23
    buffer_store_dwordx2 v[8:9], v136, s[32:35], s56 offen
    buffer_store_dwordx2 v[12:13], v137, s[32:35], s56 offen
    buffer_store_dwordx2 v[16:17], v138, s[32:35], s56 offen
    buffer_store_dwordx2 v[20:21], v139, s[32:35], s56 offen
    v_cvt_pk_bf16_f32 v24, v24, v25
    v_cvt_pk_bf16_f32 v25, v26, v27
    v_cvt_pk_bf16_f32 v28, v28, v29
    v_cvt_pk_bf16_f32 v29, v30, v31
    v_cvt_pk_bf16_f32 v32, v32, v33
    v_cvt_pk_bf16_f32 v33, v34, v35
    v_cvt_pk_bf16_f32 v36, v36, v37
    v_cvt_pk_bf16_f32 v37, v38, v39
    buffer_store_dwordx2 v[24:25], v140, s[32:35], s56 offen
    buffer_store_dwordx2 v[28:29], v141, s[32:35], s56 offen
    buffer_store_dwordx2 v[32:33], v142, s[32:35], s56 offen
    buffer_store_dwordx2 v[36:37], v143, s[32:35], s56 offen
    s_add_u32 s56, s55, 2560
    v_cvt_pk_bf16_f32 v40, v40, v41
    v_cvt_pk_bf16_f32 v41, v42, v43
    v_cvt_pk_bf16_f32 v44, v44, v45
    v_cvt_pk_bf16_f32 v45, v46, v47
    v_cvt_pk_bf16_f32 v48, v48, v49
    v_cvt_pk_bf16_f32 v49, v50, v51
    v_cvt_pk_bf16_f32 v52, v52, v53
    v_cvt_pk_bf16_f32 v53, v54, v55
    buffer_store_dwordx2 v[40:41], v136, s[32:35], s56 offen
    buffer_store_dwordx2 v[44:45], v137, s[32:35], s56 offen
    buffer_store_dwordx2 v[48:49], v138, s[32:35], s56 offen
    buffer_store_dwordx2 v[52:53], v139, s[32:35], s56 offen
    v_cvt_pk_bf16_f32 v56, v56, v57
    v_cvt_pk_bf16_f32 v57, v58, v59
    v_cvt_pk_bf16_f32 v60, v60, v61
    v_cvt_pk_bf16_f32 v61, v62, v63
    v_cvt_pk_bf16_f32 v64, v64, v65
    v_cvt_pk_bf16_f32 v65, v66, v67
    v_cvt_pk_bf16_f32 v68, v68, v69
    v_cvt_pk_bf16_f32 v69, v70, v71
    buffer_store_dwordx2 v[56:57], v140, s[32:35], s56 offen
    buffer_store_dwordx2 v[60:61], v141, s[32:35], s56 offen
    buffer_store_dwordx2 v[64:65], v142, s[32:35], s56 offen
    buffer_store_dwordx2 v[68:69], v143, s[32:35], s56 offen
    s_add_u32 s56, s55, 5120
    v_cvt_pk_bf16_f32 v72, v72, v73
    v_cvt_pk_bf16_f32 v73, v74, v75
    v_cvt_pk_bf16_f32 v76, v76, v77
    v_cvt_pk_bf16_f32 v77, v78, v79
    v_cvt_pk_bf16_f32 v80, v80, v81
    v_cvt_pk_bf16_f32 v81, v82, v83
    v_cvt_pk_bf16_f32 v84, v84, v85
    v_cvt_pk_bf16_f32 v85, v86, v87
    buffer_store_dwordx2 v[72:73], v136, s[32:35], s56 offen
    buffer_store_dwordx2 v[76:77], v137, s[32:35], s56 offen
    buffer_store_dwordx2 v[80:81], v138, s[32:35], s56 offen
    buffer_store_dwordx2 v[84:85], v139, s[32:35], s56 offen
    v_cvt_pk_bf16_f32 v88, v88, v89
    v_cvt_pk_bf16_f32 v89, v90, v91
    v_cvt_pk_bf16_f32 v92, v92, v93
    v_cvt_pk_bf16_f32 v93, v94, v95
    v_cvt_pk_bf16_f32 v96, v96, v97
    v_cvt_pk_bf16_f32 v97, v98, v99
    v_cvt_pk_bf16_f32 v100, v100, v101
    v_cvt_pk_bf16_f32 v101, v102, v103
    buffer_store_dwordx2 v[88:89], v140, s[32:35], s56 offen
    buffer_store_dwordx2 v[92:93], v141, s[32:35], s56 offen
    buffer_store_dwordx2 v[96:97], v142, s[32:35], s56 offen
    buffer_store_dwordx2 v[100:101], v143, s[32:35], s56 offen
    s_add_u32 s56, s55, 7680
    v_cvt_pk_bf16_f32 v104, v104, v105
    v_cvt_pk_bf16_f32 v105, v106, v107
    v_cvt_pk_bf16_f32 v108, v108, v109
    v_cvt_pk_bf16_f32 v109, v110, v111
    v_cvt_pk_bf16_f32 v112, v112, v113
    v_cvt_pk_bf16_f32 v113, v114, v115
    v_cvt_pk_bf16_f32 v116, v116, v117
    v_cvt_pk_bf16_f32 v117, v118, v119
    buffer_store_dwordx2 v[104:105], v136, s[32:35], s56 offen
    buffer_store_dwordx2 v[108:109], v137, s[32:35], s56 offen
    buffer_store_dwordx2 v[112:113], v138, s[32:35], s56 offen
    buffer_store_dwordx2 v[116:117], v139, s[32:35], s56 offen
    v_cvt_pk_bf16_f32 v120, v120, v121
    v_cvt_pk_bf16_f32 v121, v122, v123
    v_cvt_pk_bf16_f32 v124, v124, v125
    v_cvt_pk_bf16_f32 v125, v126, v127
    v_cvt_pk_bf16_f32 v128, v128, v129
    v_cvt_pk_bf16_f32 v129, v130, v131
    v_cvt_pk_bf16_f32 v132, v132, v133
    v_cvt_pk_bf16_f32 v133, v134, v135
    buffer_store_dwordx2 v[120:121], v140, s[32:35], s56 offen
    buffer_store_dwordx2 v[124:125], v141, s[32:35], s56 offen
    buffer_store_dwordx2 v[128:129], v142, s[32:35], s56 offen
    buffer_store_dwordx2 v[132:133], v143, s[32:35], s56 offen
    s_endpgm
K1_loopN:
    ds_read_b64_tr_b16 v[200:201], v236 offset:0
    ds_read_b64_tr_b16 v[202:203], v236 offset:1024
    ds_read_b64_tr_b16 v[204:205], v237 offset:0
    ds_read_b64_tr_b16 v[206:207], v237 offset:1024
    ds_read_b128 v[136:139], v232 offset:0
    ds_read_b128 v[140:143], v232 offset:4096
    ds_read_b128 v[144:147], v232 offset:8192
    ds_read_b128 v[148:151], v232 offset:12288
    v_add_u32 v232, 49152, v232
    ds_read_b64_tr_b16 v[208:209], v236 offset:4096
    ds_read_b64_tr_b16 v[210:211], v236 offset:5120
    ds_read_b64_tr_b16 v[212:213], v237 offset:4096
    ds_read_b64_tr_b16 v[214:215], v237 offset:5120
    ds_read_b128 v[152:155], v233 offset:0
    ds_read_b128 v[156:159], v233 offset:4096
    ds_read_b128 v[160:163], v233 offset:8192
    ds_read_b128 v[164:167], v233 offset:12288
    v_add_u32 v233, 49152, v233
    s_mov_b32 s53, 10
    s_mov_b32 s63, 1
    s_mov_b32 s64, 1
K1_loopN_l:
    s_waitcnt lgkmcnt(8)
    v_mfma_f32_32x32x16_bf16 v[8:23], v[136:139], v[200:203], v[8:23]
    s_add_u32 s55, s50, 49152
    s_cmp_eq_u32 s55, 147456
    s_cselect_b32 s55, 0, s55
    s_sub_u32 s51, s55, s50
    ds_read_b64_tr_b16 v[216:217], v236 offset:8192
    v_mfma_f32_32x32x16_bf16 v[40:55], v[140:143], v[200:203], v[40:55]
    s_add_u32 s56, s55, 49152
    s_cmp_eq_u32 s56, 147456
    s_cselect_b32 s56, 0, s56
    s_sub_u32 s52, s56, s55
    s_mov_b32 s50, s55
    ds_read_b64_tr_b16 v[218:219], v236 offset:9216
    v_mfma_f32_32x32x16_bf16 v[72:87], v[144:147], v[200:203], v[72:87]
    ds_read_b64_tr_b16 v[220:221], v237 offset:8192
    v_mfma_f32_32x32x16_bf16 v[104:119], v[148:151], v[200:203], v[104:119]
    ds_read_b64_tr_b16 v[222:223], v237 offset:9216
    v_mfma_f32_32x32x16_bf16 v[24:39], v[136:139], v[204:207], v[24:39]
    ds_read_b128 v[168:171], v234 offset:0
    v_mfma_f32_32x32x16_bf16 v[56:71], v[140:143], v[204:207], v[56:71]
    ds_read_b128 v[172:175], v234 offset:4096
    v_mfma_f32_32x32x16_bf16 v[88:103], v[144:147], v[204:207], v[88:103]
    ds_read_b128 v[176:179], v234 offset:8192
    v_mfma_f32_32x32x16_bf16 v[120:135], v[148:151], v[204:207], v[120:135]
    ds_read_b128 v[180:183], v234 offset:12288
    v_add_u32 v234, s51, v234
    s_waitcnt lgkmcnt(8)
    v_mfma_f32_32x32x16_bf16 v[8:23], v[152:155], v[208:211], v[8:23]
    ds_read_b64 v[240:241], v238
    ds_read_b64_tr_b16 v[224:225], v236 offset:12288
    v_mfma_f32_32x32x16_bf16 v[40:55], v[156:159], v[208:211], v[40:55]
    ds_read_b64_tr_b16 v[226:227], v236 offset:13312
    ds_read_b64_tr_b16 v[228:229], v237 offset:12288
    v_mfma_f32_32x32x16_bf16 v[72:87], v[160:163], v[208:211], v[72:87]
    ds_read_b64_tr_b16 v[230:231], v237 offset:13312
    ds_read_b128 v[184:187], v235 offset:0
    v_mfma_f32_32x32x16_bf16 v[104:119], v[164:167], v[208:211], v[104:119]
    ds_read_b128 v[188:191], v235 offset:4096
    ds_read_b128 v[192:195], v235 offset:8192
    v_mfma_f32_32x32x16_bf16 v[24:39], v[152:155], v[212:215], v[24:39]
    ds_read_b128 v[196:199], v235 offset:12288
    v_mfma_f32_32x32x16_bf16 v[56:71], v[156:159], v[212:215], v[56:71]
    v_mfma_f32_32x32x16_bf16 v[88:103], v[160:163], v[212:215], v[88:103]
    v_mfma_f32_32x32x16_bf16 v[120:135], v[164:167], v[212:215], v[120:135]
    v_add_u32 v235, s51, v235
    s_waitcnt lgkmcnt(0)
    v_mfma_f32_32x32x16_bf16 v[8:23], v[168:171], v[216:219], v[8:23]
    v_add_u32 v243, s66, v242
    v_min_u32 v240, v240, v241
    s_mov_b64 exec, 1
    ds_add_u32 v243, v239
    s_mov_b64 exec, -1
    v_mfma_f32_32x32x16_bf16 v[40:55], v[172:175], v[216:219], v[40:55]
    v_readfirstlane_b32 s62, v240
    v_add_u32 v236, s51, v236
    v_add_u32 v237, s51, v237
    s_add_u32 s66, s66, 4
    s_cmp_eq_u32 s66, 12
    s_cselect_b32 s66, 0, s66
    v_mfma_f32_32x32x16_bf16 v[72:87], v[176:179], v[216:219], v[72:87]
    s_cmp_ge_u32 s62, s63
    s_cbranch_scc1 K1_loopN_l_rdy
K1_loopN_l_sp:
    ds_read_b64 v[240:241], v238
    s_waitcnt lgkmcnt(0)
    v_min_u32 v240, v240, v241
    s_nop 0
    v_readfirstlane_b32 s62, v240
    s_nop 3
    s_cmp_ge_u32 s62, s63
    s_cbranch_scc1 K1_loopN_l_sp_ok
    s_sleep 1
    s_branch K1_loopN_l_sp
K1_loopN_l_sp_ok:
K1_loopN_l_rdy:
    v_xor_b32 v238, 8, v238
    s_add_u32 s64, s64, 1
    s_lshr_b32 s63, s64, 1
    s_add_u32 s63, s63, 1
    s_cmp_ge_u32 s64, 10
    s_cselect_b32 s63, 0, s63
    v_mfma_f32_32x32x16_bf16 v[104:119], v[180:183], v[216:219], v[104:119]
    ds_read_b64_tr_b16 v[200:201], v236 offset:0
    ds_read_b64_tr_b16 v[202:203], v236 offset:1024
    v_mfma_f32_32x32x16_bf16 v[24:39], v[168:171], v[220:223], v[24:39]
    ds_read_b64_tr_b16 v[204:205], v237 offset:0
    ds_read_b64_tr_b16 v[206:207], v237 offset:1024
    v_mfma_f32_32x32x16_bf16 v[56:71], v[172:175], v[220:223], v[56:71]
    ds_read_b128 v[136:139], v232 offset:0
    ds_read_b128 v[140:143], v232 offset:4096
    v_mfma_f32_32x32x16_bf16 v[88:103], v[176:179], v[220:223], v[88:103]
    ds_read_b128 v[144:147], v232 offset:8192
    ds_read_b128 v[148:151], v232 offset:12288
    v_mfma_f32_32x32x16_bf16 v[120:135], v[180:183], v[220:223], v[120:135]
    v_add_u32 v232, s52, v232
    s_waitcnt lgkmcnt(8)
    v_mfma_f32_32x32x16_bf16 v[8:23], v[184:187], v[224:227], v[8:23]
    ds_read_b64_tr_b16 v[208:209], v236 offset:4096
    v_mfma_f32_32x32x16_bf16 v[40:55], v[188:191], v[224:227], v[40:55]
    ds_read_b64_tr_b16 v[210:211], v236 offset:5120
    v_mfma_f32_32x32x16_bf16 v[72:87], v[192:195], v[224:227], v[72:87]
    ds_read_b64_tr_b16 v[212:213], v237 offset:4096
    v_mfma_f32_32x32x16_bf16 v[104:119], v[196:199], v[224:227], v[104:119]
    ds_read_b64_tr_b16 v[214:215], v237 offset:5120
    v_mfma_f32_32x32x16_bf16 v[24:39], v[184:187], v[228:231], v[24:39]
    ds_read_b128 v[152:155], v233 offset:0
    v_mfma_f32_32x32x16_bf16 v[56:71], v[188:191], v[228:231], v[56:71]
    ds_read_b128 v[156:159], v233 offset:4096
    v_mfma_f32_32x32x16_bf16 v[88:103], v[192:195], v[228:231], v[88:103]
    ds_read_b128 v[160:163], v233 offset:8192
    v_mfma_f32_32x32x16_bf16 v[120:135], v[196:199], v[228:231], v[120:135]
    ds_read_b128 v[164:167], v233 offset:12288
    v_add_u32 v233, s52, v233
    s_sub_u32 s53, s53, 1
    s_cmp_lg_u32 s53, 0
    s_cbranch_scc1 K1_loopN_l
    s_waitcnt lgkmcnt(0)
    v_and_b32 v1, 31, v0
    v_lshrrev_b32 v2, 5, v0
    s_lshl_b32 s53, s44, 8
    s_lshl_b32 s54, s60, 7
    s_add_u32 s53, s53, s54
    s_lshl_b32 s54, s61, 6
    s_add_u32 s49, s49, s54
    s_nop 7
    s_nop 7
    s_lshr_b32 s55, s53, 5
    s_mul_i32 s55, s55, 2560
    s_mov_b32 s56, 10485760
    s_cmp_eq_u32 s46, 1
    s_cselect_b32 s56, 2621440, s56
    s_add_u32 s55, s55, s56
    s_cmp_eq_u32 s47, 2
    s_cselect_b32 s56, 1280, 0
    s_add_u32 s55, s55, s56
    s_mov_b32 s57, 163840
    s_mov_b32 s58, 1069066811
    s_mov_b32 s59, 1069066811
    s_mov_b32 s60, 897988541
    s_mov_b32 s61, 897988541
    v_mul_u32_u24 v3, 320, v2
    v_add_u32 v4, s49, v1
    s_cmp_eq_u32 s47, 1
    s_cbranch_scc1 K1_epiPK
    v_add_u32 v5, 0, v4
    v_mul_u32_u24 v6, 205, v5
    v_lshrrev_b32 v6, 12, v6
    v_mul_u32_u24 v7, 20, v6
    v_sub_u32 v7, v5, v7
    v_mul_lo_u32 v6, s57, v6
    v_lshl_add_u32 v6, v7, 4, v6
    v_add_u32 v136, v6, v3
    v_add_u32 v5, 32, v4
    v_mul_u32_u24 v6, 205, v5
    v_lshrrev_b32 v6, 12, v6
    v_mul_u32_u24 v7, 20, v6
    v_sub_u32 v7, v5, v7
    v_mul_lo_u32 v6, s57, v6
    v_lshl_add_u32 v6, v7, 4, v6
    v_add_u32 v137, v6, v3
    v_cvt_pk_bf16_f32 v8, v8, v9
    v_cvt_pk_bf16_f32 v9, v10, v11
    v_cvt_pk_bf16_f32 v10, v12, v13
    v_cvt_pk_bf16_f32 v11, v14, v15
    v_cvt_pk_bf16_f32 v16, v16, v17
    v_cvt_pk_bf16_f32 v17, v18, v19
    v_cvt_pk_bf16_f32 v18, v20, v21
    v_cvt_pk_bf16_f32 v19, v22, v23
    s_add_u32 s56, s55, 0
    buffer_store_dwordx4 v[8:11], v136, s[32:35], s56 offen
    s_add_u32 s56, s55, 640
    buffer_store_dwordx4 v[16:19], v136, s[32:35], s56 offen
    v_cvt_pk_bf16_f32 v24, v24, v25
    v_cvt_pk_bf16_f32 v25, v26, v27
    v_cvt_pk_bf16_f32 v26, v28, v29
    v_cvt_pk_bf16_f32 v27, v30, v31
    v_cvt_pk_bf16_f32 v32, v32, v33
    v_cvt_pk_bf16_f32 v33, v34, v35
    v_cvt_pk_bf16_f32 v34, v36, v37
    v_cvt_pk_bf16_f32 v35, v38, v39
    s_add_u32 s56, s55, 0
    buffer_store_dwordx4 v[24:27], v137, s[32:35], s56 offen
    s_add_u32 s56, s55, 640
    buffer_store_dwordx4 v[32:35], v137, s[32:35], s56 offen
    v_cvt_pk_bf16_f32 v40, v40, v41
    v_cvt_pk_bf16_f32 v41, v42, v43
    v_cvt_pk_bf16_f32 v42, v44, v45
    v_cvt_pk_bf16_f32 v43, v46, v47
    v_cvt_pk_bf16_f32 v48, v48, v49
    v_cvt_pk_bf16_f32 v49, v50, v51
    v_cvt_pk_bf16_f32 v50, v52, v53
    v_cvt_pk_bf16_f32 v51, v54, v55
    s_add_u32 s56, s55, 2560
    buffer_store_dwordx4 v[40:43], v136, s[32:35], s56 offen
    s_add_u32 s56, s55, 3200
    buffer_store_dwordx4 v[48:51], v136, s[32:35], s56 offen
    v_cvt_pk_bf16_f32 v56, v56, v57
    v_cvt_pk_bf16_f32 v57, v58, v59
    v_cvt_pk_bf16_f32 v58, v60, v61
    v_cvt_pk_bf16_f32 v59, v62, v63
    v_cvt_pk_bf16_f32 v64, v64, v65
    v_cvt_pk_bf16_f32 v65, v66, v67
    v_cvt_pk_bf16_f32 v66, v68, v69
    v_cvt_pk_bf16_f32 v67, v70, v71
    s_add_u32 s56, s55, 2560
    buffer_store_dwordx4 v[56:59], v137, s[32:35], s56 offen
    s_add_u32 s56, s55, 3200
    buffer_store_dwordx4 v[64:67], v137, s[32:35], s56 offen
    v_cvt_pk_bf16_f32 v72, v72, v73
    v_cvt_pk_bf16_f32 v73, v74, v75
    v_cvt_pk_bf16_f32 v74, v76, v77
    v_cvt_pk_bf16_f32 v75, v78, v79
    v_cvt_pk_bf16_f32 v80, v80, v81
    v_cvt_pk_bf16_f32 v81, v82, v83
    v_cvt_pk_bf16_f32 v82, v84, v85
    v_cvt_pk_bf16_f32 v83, v86, v87
    s_add_u32 s56, s55, 5120
    buffer_store_dwordx4 v[72:75], v136, s[32:35], s56 offen
    s_add_u32 s56, s55, 5760
    buffer_store_dwordx4 v[80:83], v136, s[32:35], s56 offen
    v_cvt_pk_bf16_f32 v88, v88, v89
    v_cvt_pk_bf16_f32 v89, v90, v91
    v_cvt_pk_bf16_f32 v90, v92, v93
    v_cvt_pk_bf16_f32 v91, v94, v95
    v_cvt_pk_bf16_f32 v96, v96, v97
    v_cvt_pk_bf16_f32 v97, v98, v99
    v_cvt_pk_bf16_f32 v98, v100, v101
    v_cvt_pk_bf16_f32 v99, v102, v103
    s_add_u32 s56, s55, 5120
    buffer_store_dwordx4 v[88:91], v137, s[32:35], s56 offen
    s_add_u32 s56, s55, 5760
    buffer_store_dwordx4 v[96:99], v137, s[32:35], s56 offen
    v_cvt_pk_bf16_f32 v104, v104, v105
    v_cvt_pk_bf16_f32 v105, v106, v107
    v_cvt_pk_bf16_f32 v106, v108, v109
    v_cvt_pk_bf16_f32 v107, v110, v111
    v_cvt_pk_bf16_f32 v112, v112, v113
    v_cvt_pk_bf16_f32 v113, v114, v115
    v_cvt_pk_bf16_f32 v114, v116, v117
    v_cvt_pk_bf16_f32 v115, v118, v119
    s_add_u32 s56, s55, 7680
    buffer_store_dwordx4 v[104:107], v136, s[32:35], s56 offen
    s_add_u32 s56, s55, 8320
    buffer_store_dwordx4 v[112:115], v136, s[32:35], s56 offen
    v_cvt_pk_bf16_f32 v120, v120, v121
    v_cvt_pk_bf16_f32 v121, v122, v123
    v_cvt_pk_bf16_f32 v122, v124, v125
    v_cvt_pk_bf16_f32 v123, v126, v127
    v_cvt_pk_bf16_f32 v128, v128, v129
    v_cvt_pk_bf16_f32 v129, v130, v131
    v_cvt_pk_bf16_f32 v130, v132, v133
    v_cvt_pk_bf16_f32 v131, v134, v135
    s_add_u32 s56, s55, 7680
    buffer_store_dwordx4 v[120:123], v137, s[32:35], s56 offen
    s_add_u32 s56, s55, 8320
    buffer_store_dwordx4 v[128:131], v137, s[32:35], s56 offen
    s_endpgm
K1_epiPK:
    v_add_u32 v5, 0, v4
    v_mul_u32_u24 v6, 205, v5
    v_lshrrev_b32 v6, 12, v6
    v_mul_u32_u24 v7, 20, v6
    v_sub_u32 v7, v5, v7
    v_mul_lo_u32 v6, s57, v6
    v_lshl_add_u32 v6, v7, 4, v6
    v_add_u32 v136, v6, v3
    v_add_u32 v5, 32, v4
    v_mul_u32_u24 v6, 205, v5
    v_lshrrev_b32 v6, 12, v6
    v_mul_u32_u24 v7, 20, v6
    v_sub_u32 v7, v5, v7
    v_mul_lo_u32 v6, s57, v6
    v_lshl_add_u32 v6, v7, 4, v6
    v_add_u32 v137, v6, v3
    v_pk_mul_f32 v[144:145], v[8:9], s[58:59]
    v_pk_mul_f32 v[146:147], v[10:11], s[58:59]
    v_pk_mul_f32 v[148:149], v[12:13], s[58:59]
    v_pk_mul_f32 v[150:151], v[14:15], s[58:59]
    v_pk_mul_f32 v[152:153], v[16:17], s[58:59]
    v_pk_mul_f32 v[154:155], v[18:19], s[58:59]
    v_pk_mul_f32 v[156:157], v[20:21], s[58:59]
    v_pk_mul_f32 v[158:159], v[22:23], s[58:59]
    v_min_f32 v144, 0, v144
    v_min_f32 v145, 0, v145
    v_min_f32 v146, 0, v146
    v_min_f32 v147, 0, v147
    v_min_f32 v148, 0, v148
    v_min_f32 v149, 0, v149
    v_min_f32 v150, 0, v150
    v_min_f32 v151, 0, v151
    v_min_f32 v152, 0, v152
    v_min_f32 v153, 0, v153
    v_min_f32 v154, 0, v154
    v_min_f32 v155, 0, v155
    v_min_f32 v156, 0, v156
    v_min_f32 v157, 0, v157
    v_min_f32 v158, 0, v158
    v_min_f32 v159, 0, v159
    v_exp_f32 v144, v144
    v_exp_f32 v145, v145
    v_exp_f32 v146, v146
    v_exp_f32 v147, v147
    v_exp_f32 v148, v148
    v_exp_f32 v149, v149
    v_exp_f32 v150, v150
    v_exp_f32 v151, v151
    v_exp_f32 v152, v152
    v_exp_f32 v153, v153
    v_exp_f32 v154, v154
    v_exp_f32 v155, v155
    v_exp_f32 v156, v156
    v_exp_f32 v157, v157
    v_exp_f32 v158, v158
    v_exp_f32 v159, v159
    v_pk_add_f32 v[8:9], v[8:9], s[60:61]
    v_pk_add_f32 v[10:11], v[10:11], s[60:61]
    v_pk_add_f32 v[12:13], v[12:13], s[60:61]
    v_pk_add_f32 v[14:15], v[14:15], s[60:61]
    v_pk_add_f32 v[16:17], v[16:17], s[60:61]
    v_pk_add_f32 v[18:19], v[18:19], s[60:61]
    v_pk_add_f32 v[20:21], v[20:21], s[60:61]
    v_pk_add_f32 v[22:23], v[22:23], s[60:61]
    v_max_f32 v8, s60, v8
    v_max_f32 v9, s60, v9
    v_max_f32 v10, s60, v10
    v_max_f32 v11, s60, v11
    v_max_f32 v12, s60, v12
    v_max_f32 v13, s60, v13
    v_max_f32 v14, s60, v14
    v_max_f32 v15, s60, v15
    v_max_f32 v16, s60, v16
    v_max_f32 v17, s60, v17
    v_max_f32 v18, s60, v18
    v_max_f32 v19, s60, v19
    v_max_f32 v20, s60, v20
    v_max_f32 v21, s60, v21
    v_max_f32 v22, s60, v22
    v_max_f32 v23, s60, v23
    v_pk_add_f32 v[8:9], v[8:9], v[144:145]
    v_pk_add_f32 v[10:11], v[10:11], v[146:147]
    v_pk_add_f32 v[12:13], v[12:13], v[148:149]
    v_pk_add_f32 v[14:15], v[14:15], v[150:151]
    v_pk_add_f32 v[16:17], v[16:17], v[152:153]
    v_pk_add_f32 v[18:19], v[18:19], v[154:155]
    v_pk_add_f32 v[20:21], v[20:21], v[156:157]
    v_pk_add_f32 v[22:23], v[22:23], v[158:159]
    v_cvt_pk_bf16_f32 v8, v8, v9
    v_cvt_pk_bf16_f32 v9, v10, v11
    v_cvt_pk_bf16_f32 v10, v12, v13
    v_cvt_pk_bf16_f32 v11, v14, v15
    v_cvt_pk_bf16_f32 v16, v16, v17
    v_cvt_pk_bf16_f32 v17, v18, v19
    v_cvt_pk_bf16_f32 v18, v20, v21
    v_cvt_pk_bf16_f32 v19, v22, v23
    s_add_u32 s56, s55, 0
    buffer_store_dwordx4 v[8:11], v136, s[32:35], s56 offen
    s_add_u32 s56, s55, 640
    buffer_store_dwordx4 v[16:19], v136, s[32:35], s56 offen
    v_pk_mul_f32 v[144:145], v[24:25], s[58:59]
    v_pk_mul_f32 v[146:147], v[26:27], s[58:59]
    v_pk_mul_f32 v[148:149], v[28:29], s[58:59]
    v_pk_mul_f32 v[150:151], v[30:31], s[58:59]
    v_pk_mul_f32 v[152:153], v[32:33], s[58:59]
    v_pk_mul_f32 v[154:155], v[34:35], s[58:59]
    v_pk_mul_f32 v[156:157], v[36:37], s[58:59]
    v_pk_mul_f32 v[158:159], v[38:39], s[58:59]
    v_min_f32 v144, 0, v144
    v_min_f32 v145, 0, v145
    v_min_f32 v146, 0, v146
    v_min_f32 v147, 0, v147
    v_min_f32 v148, 0, v148
    v_min_f32 v149, 0, v149
    v_min_f32 v150, 0, v150
    v_min_f32 v151, 0, v151
    v_min_f32 v152, 0, v152
    v_min_f32 v153, 0, v153
    v_min_f32 v154, 0, v154
    v_min_f32 v155, 0, v155
    v_min_f32 v156, 0, v156
    v_min_f32 v157, 0, v157
    v_min_f32 v158, 0, v158
    v_min_f32 v159, 0, v159
    v_exp_f32 v144, v144
    v_exp_f32 v145, v145
    v_exp_f32 v146, v146
    v_exp_f32 v147, v147
    v_exp_f32 v148, v148
    v_exp_f32 v149, v149
    v_exp_f32 v150, v150
    v_exp_f32 v151, v151
    v_exp_f32 v152, v152
    v_exp_f32 v153, v153
    v_exp_f32 v154, v154
    v_exp_f32 v155, v155
    v_exp_f32 v156, v156
    v_exp_f32 v157, v157
    v_exp_f32 v158, v158
    v_exp_f32 v159, v159
    v_pk_add_f32 v[24:25], v[24:25], s[60:61]
    v_pk_add_f32 v[26:27], v[26:27], s[60:61]
    v_pk_add_f32 v[28:29], v[28:29], s[60:61]
    v_pk_add_f32 v[30:31], v[30:31], s[60:61]
    v_pk_add_f32 v[32:33], v[32:33], s[60:61]
    v_pk_add_f32 v[34:35], v[34:35], s[60:61]
    v_pk_add_f32 v[36:37], v[36:37], s[60:61]
    v_pk_add_f32 v[38:39], v[38:39], s[60:61]
    v_max_f32 v24, s60, v24
    v_max_f32 v25, s60, v25
    v_max_f32 v26, s60, v26
    v_max_f32 v27, s60, v27
    v_max_f32 v28, s60, v28
    v_max_f32 v29, s60, v29
    v_max_f32 v30, s60, v30
    v_max_f32 v31, s60, v31
    v_max_f32 v32, s60, v32
    v_max_f32 v33, s60, v33
    v_max_f32 v34, s60, v34
    v_max_f32 v35, s60, v35
    v_max_f32 v36, s60, v36
    v_max_f32 v37, s60, v37
    v_max_f32 v38, s60, v38
    v_max_f32 v39, s60, v39
    v_pk_add_f32 v[24:25], v[24:25], v[144:145]
    v_pk_add_f32 v[26:27], v[26:27], v[146:147]
    v_pk_add_f32 v[28:29], v[28:29], v[148:149]
    v_pk_add_f32 v[30:31], v[30:31], v[150:151]
    v_pk_add_f32 v[32:33], v[32:33], v[152:153]
    v_pk_add_f32 v[34:35], v[34:35], v[154:155]
    v_pk_add_f32 v[36:37], v[36:37], v[156:157]
    v_pk_add_f32 v[38:39], v[38:39], v[158:159]
    v_cvt_pk_bf16_f32 v24, v24, v25
    v_cvt_pk_bf16_f32 v25, v26, v27
    v_cvt_pk_bf16_f32 v26, v28, v29
    v_cvt_pk_bf16_f32 v27, v30, v31
    v_cvt_pk_bf16_f32 v32, v32, v33
    v_cvt_pk_bf16_f32 v33, v34, v35
    v_cvt_pk_bf16_f32 v34, v36, v37
    v_cvt_pk_bf16_f32 v35, v38, v39
    s_add_u32 s56, s55, 0
    buffer_store_dwordx4 v[24:27], v137, s[32:35], s56 offen
    s_add_u32 s56, s55, 640
    buffer_store_dwordx4 v[32:35], v137, s[32:35], s56 offen
    v_pk_mul_f32 v[144:145], v[40:41], s[58:59]
    v_pk_mul_f32 v[146:147], v[42:43], s[58:59]
    v_pk_mul_f32 v[148:149], v[44:45], s[58:59]
    v_pk_mul_f32 v[150:151], v[46:47], s[58:59]
    v_pk_mul_f32 v[152:153], v[48:49], s[58:59]
    v_pk_mul_f32 v[154:155], v[50:51], s[58:59]
    v_pk_mul_f32 v[156:157], v[52:53], s[58:59]
    v_pk_mul_f32 v[158:159], v[54:55], s[58:59]
    v_min_f32 v144, 0, v144
    v_min_f32 v145, 0, v145
    v_min_f32 v146, 0, v146
    v_min_f32 v147, 0, v147
    v_min_f32 v148, 0, v148
    v_min_f32 v149, 0, v149
    v_min_f32 v150, 0, v150
    v_min_f32 v151, 0, v151
    v_min_f32 v152, 0, v152
    v_min_f32 v153, 0, v153
    v_min_f32 v154, 0, v154
    v_min_f32 v155, 0, v155
    v_min_f32 v156, 0, v156
    v_min_f32 v157, 0, v157
    v_min_f32 v158, 0, v158
    v_min_f32 v159, 0, v159
    v_exp_f32 v144, v144
    v_exp_f32 v145, v145
    v_exp_f32 v146, v146
    v_exp_f32 v147, v147
    v_exp_f32 v148, v148
    v_exp_f32 v149, v149
    v_exp_f32 v150, v150
    v_exp_f32 v151, v151
    v_exp_f32 v152, v152
    v_exp_f32 v153, v153
    v_exp_f32 v154, v154
    v_exp_f32 v155, v155
    v_exp_f32 v156, v156
    v_exp_f32 v157, v157
    v_exp_f32 v158, v158
    v_exp_f32 v159, v159
    v_pk_add_f32 v[40:41], v[40:41], s[60:61]
    v_pk_add_f32 v[42:43], v[42:43], s[60:61]
    v_pk_add_f32 v[44:45], v[44:45], s[60:61]
    v_pk_add_f32 v[46:47], v[46:47], s[60:61]
    v_pk_add_f32 v[48:49], v[48:49], s[60:61]
    v_pk_add_f32 v[50:51], v[50:51], s[60:61]
    v_pk_add_f32 v[52:53], v[52:53], s[60:61]
    v_pk_add_f32 v[54:55], v[54:55], s[60:61]
    v_max_f32 v40, s60, v40
    v_max_f32 v41, s60, v41
    v_max_f32 v42, s60, v42
    v_max_f32 v43, s60, v43
    v_max_f32 v44, s60, v44
    v_max_f32 v45, s60, v45
    v_max_f32 v46, s60, v46
    v_max_f32 v47, s60, v47
    v_max_f32 v48, s60, v48
    v_max_f32 v49, s60, v49
    v_max_f32 v50, s60, v50
    v_max_f32 v51, s60, v51
    v_max_f32 v52, s60, v52
    v_max_f32 v53, s60, v53
    v_max_f32 v54, s60, v54
    v_max_f32 v55, s60, v55
    v_pk_add_f32 v[40:41], v[40:41], v[144:145]
    v_pk_add_f32 v[42:43], v[42:43], v[146:147]
    v_pk_add_f32 v[44:45], v[44:45], v[148:149]
    v_pk_add_f32 v[46:47], v[46:47], v[150:151]
    v_pk_add_f32 v[48:49], v[48:49], v[152:153]
    v_pk_add_f32 v[50:51], v[50:51], v[154:155]
    v_pk_add_f32 v[52:53], v[52:53], v[156:157]
    v_pk_add_f32 v[54:55], v[54:55], v[158:159]
    v_cvt_pk_bf16_f32 v40, v40, v41
    v_cvt_pk_bf16_f32 v41, v42, v43
    v_cvt_pk_bf16_f32 v42, v44, v45
    v_cvt_pk_bf16_f32 v43, v46, v47
    v_cvt_pk_bf16_f32 v48, v48, v49
    v_cvt_pk_bf16_f32 v49, v50, v51
    v_cvt_pk_bf16_f32 v50, v52, v53
    v_cvt_pk_bf16_f32 v51, v54, v55
    s_add_u32 s56, s55, 2560
    buffer_store_dwordx4 v[40:43], v136, s[32:35], s56 offen
    s_add_u32 s56, s55, 3200
    buffer_store_dwordx4 v[48:51], v136, s[32:35], s56 offen
    v_pk_mul_f32 v[144:145], v[56:57], s[58:59]
    v_pk_mul_f32 v[146:147], v[58:59], s[58:59]
    v_pk_mul_f32 v[148:149], v[60:61], s[58:59]
    v_pk_mul_f32 v[150:151], v[62:63], s[58:59]
    v_pk_mul_f32 v[152:153], v[64:65], s[58:59]
    v_pk_mul_f32 v[154:155], v[66:67], s[58:59]
    v_pk_mul_f32 v[156:157], v[68:69], s[58:59]
    v_pk_mul_f32 v[158:159], v[70:71], s[58:59]
    v_min_f32 v144, 0, v144
    v_min_f32 v145, 0, v145
    v_min_f32 v146, 0, v146
    v_min_f32 v147, 0, v147
    v_min_f32 v148, 0, v148
    v_min_f32 v149, 0, v149
    v_min_f32 v150, 0, v150
    v_min_f32 v151, 0, v151
    v_min_f32 v152, 0, v152
    v_min_f32 v153, 0, v153
    v_min_f32 v154, 0, v154
    v_min_f32 v155, 0, v155
    v_min_f32 v156, 0, v156
    v_min_f32 v157, 0, v157
    v_min_f32 v158, 0, v158
    v_min_f32 v159, 0, v159
    v_exp_f32 v144, v144
    v_exp_f32 v145, v145
    v_exp_f32 v146, v146
    v_exp_f32 v147, v147
    v_exp_f32 v148, v148
    v_exp_f32 v149, v149
    v_exp_f32 v150, v150
    v_exp_f32 v151, v151
    v_exp_f32 v152, v152
    v_exp_f32 v153, v153
    v_exp_f32 v154, v154
    v_exp_f32 v155, v155
    v_exp_f32 v156, v156
    v_exp_f32 v157, v157
    v_exp_f32 v158, v158
    v_exp_f32 v159, v159
    v_pk_add_f32 v[56:57], v[56:57], s[60:61]
    v_pk_add_f32 v[58:59], v[58:59], s[60:61]
    v_pk_add_f32 v[60:61], v[60:61], s[60:61]
    v_pk_add_f32 v[62:63], v[62:63], s[60:61]
    v_pk_add_f32 v[64:65], v[64:65], s[60:61]
    v_pk_add_f32 v[66:67], v[66:67], s[60:61]
    v_pk_add_f32 v[68:69], v[68:69], s[60:61]
    v_pk_add_f32 v[70:71], v[70:71], s[60:61]
    v_max_f32 v56, s60, v56
    v_max_f32 v57, s60, v57
    v_max_f32 v58, s60, v58
    v_max_f32 v59, s60, v59
    v_max_f32 v60, s60, v60
    v_max_f32 v61, s60, v61
    v_max_f32 v62, s60, v62
    v_max_f32 v63, s60, v63
    v_max_f32 v64, s60, v64
    v_max_f32 v65, s60, v65
    v_max_f32 v66, s60, v66
    v_max_f32 v67, s60, v67
    v_max_f32 v68, s60, v68
    v_max_f32 v69, s60, v69
    v_max_f32 v70, s60, v70
    v_max_f32 v71, s60, v71
    v_pk_add_f32 v[56:57], v[56:57], v[144:145]
    v_pk_add_f32 v[58:59], v[58:59], v[146:147]
    v_pk_add_f32 v[60:61], v[60:61], v[148:149]
    v_pk_add_f32 v[62:63], v[62:63], v[150:151]
    v_pk_add_f32 v[64:65], v[64:65], v[152:153]
    v_pk_add_f32 v[66:67], v[66:67], v[154:155]
    v_pk_add_f32 v[68:69], v[68:69], v[156:157]
    v_pk_add_f32 v[70:71], v[70:71], v[158:159]
    v_cvt_pk_bf16_f32 v56, v56, v57
    v_cvt_pk_bf16_f32 v57, v58, v59
    v_cvt_pk_bf16_f32 v58, v60, v61
    v_cvt_pk_bf16_f32 v59, v62, v63
    v_cvt_pk_bf16_f32 v64, v64, v65
    v_cvt_pk_bf16_f32 v65, v66, v67
    v_cvt_pk_bf16_f32 v66, v68, v69
    v_cvt_pk_bf16_f32 v67, v70, v71
    s_add_u32 s56, s55, 2560
    buffer_store_dwordx4 v[56:59], v137, s[32:35], s56 offen
    s_add_u32 s56, s55, 3200
    buffer_store_dwordx4 v[64:67], v137, s[32:35], s56 offen
    v_pk_mul_f32 v[144:145], v[72:73], s[58:59]
    v_pk_mul_f32 v[146:147], v[74:75], s[58:59]
    v_pk_mul_f32 v[148:149], v[76:77], s[58:59]
    v_pk_mul_f32 v[150:151], v[78:79], s[58:59]
    v_pk_mul_f32 v[152:153], v[80:81], s[58:59]
    v_pk_mul_f32 v[154:155], v[82:83], s[58:59]
    v_pk_mul_f32 v[156:157], v[84:85], s[58:59]
    v_pk_mul_f32 v[158:159], v[86:87], s[58:59]
    v_min_f32 v144, 0, v144
    v_min_f32 v145, 0, v145
    v_min_f32 v146, 0, v146
    v_min_f32 v147, 0, v147
    v_min_f32 v148, 0, v148
    v_min_f32 v149, 0, v149
    v_min_f32 v150, 0, v150
    v_min_f32 v151, 0, v151
    v_min_f32 v152, 0, v152
    v_min_f32 v153, 0, v153
    v_min_f32 v154, 0, v154
    v_min_f32 v155, 0, v155
    v_min_f32 v156, 0, v156
    v_min_f32 v157, 0, v157
    v_min_f32 v158, 0, v158
    v_min_f32 v159, 0, v159
    v_exp_f32 v144, v144
    v_exp_f32 v145, v145
    v_exp_f32 v146, v146
    v_exp_f32 v147, v147
    v_exp_f32 v148, v148
    v_exp_f32 v149, v149
    v_exp_f32 v150, v150
    v_exp_f32 v151, v151
    v_exp_f32 v152, v152
    v_exp_f32 v153, v153
    v_exp_f32 v154, v154
    v_exp_f32 v155, v155
    v_exp_f32 v156, v156
    v_exp_f32 v157, v157
    v_exp_f32 v158, v158
    v_exp_f32 v159, v159
    v_pk_add_f32 v[72:73], v[72:73], s[60:61]
    v_pk_add_f32 v[74:75], v[74:75], s[60:61]
    v_pk_add_f32 v[76:77], v[76:77], s[60:61]
    v_pk_add_f32 v[78:79], v[78:79], s[60:61]
    v_pk_add_f32 v[80:81], v[80:81], s[60:61]
    v_pk_add_f32 v[82:83], v[82:83], s[60:61]
    v_pk_add_f32 v[84:85], v[84:85], s[60:61]
    v_pk_add_f32 v[86:87], v[86:87], s[60:61]
    v_max_f32 v72, s60, v72
    v_max_f32 v73, s60, v73
    v_max_f32 v74, s60, v74
    v_max_f32 v75, s60, v75
    v_max_f32 v76, s60, v76
    v_max_f32 v77, s60, v77
    v_max_f32 v78, s60, v78
    v_max_f32 v79, s60, v79
    v_max_f32 v80, s60, v80
    v_max_f32 v81, s60, v81
    v_max_f32 v82, s60, v82
    v_max_f32 v83, s60, v83
    v_max_f32 v84, s60, v84
    v_max_f32 v85, s60, v85
    v_max_f32 v86, s60, v86
    v_max_f32 v87, s60, v87
    v_pk_add_f32 v[72:73], v[72:73], v[144:145]
    v_pk_add_f32 v[74:75], v[74:75], v[146:147]
    v_pk_add_f32 v[76:77], v[76:77], v[148:149]
    v_pk_add_f32 v[78:79], v[78:79], v[150:151]
    v_pk_add_f32 v[80:81], v[80:81], v[152:153]
    v_pk_add_f32 v[82:83], v[82:83], v[154:155]
    v_pk_add_f32 v[84:85], v[84:85], v[156:157]
    v_pk_add_f32 v[86:87], v[86:87], v[158:159]
    v_cvt_pk_bf16_f32 v72, v72, v73
    v_cvt_pk_bf16_f32 v73, v74, v75
    v_cvt_pk_bf16_f32 v74, v76, v77
    v_cvt_pk_bf16_f32 v75, v78, v79
    v_cvt_pk_bf16_f32 v80, v80, v81
    v_cvt_pk_bf16_f32 v81, v82, v83
    v_cvt_pk_bf16_f32 v82, v84, v85
    v_cvt_pk_bf16_f32 v83, v86, v87
    s_add_u32 s56, s55, 5120
    buffer_store_dwordx4 v[72:75], v136, s[32:35], s56 offen
    s_add_u32 s56, s55, 5760
    buffer_store_dwordx4 v[80:83], v136, s[32:35], s56 offen
    v_pk_mul_f32 v[144:145], v[88:89], s[58:59]
    v_pk_mul_f32 v[146:147], v[90:91], s[58:59]
    v_pk_mul_f32 v[148:149], v[92:93], s[58:59]
    v_pk_mul_f32 v[150:151], v[94:95], s[58:59]
    v_pk_mul_f32 v[152:153], v[96:97], s[58:59]
    v_pk_mul_f32 v[154:155], v[98:99], s[58:59]
    v_pk_mul_f32 v[156:157], v[100:101], s[58:59]
    v_pk_mul_f32 v[158:159], v[102:103], s[58:59]
    v_min_f32 v144, 0, v144
    v_min_f32 v145, 0, v145
    v_min_f32 v146, 0, v146
    v_min_f32 v147, 0, v147
    v_min_f32 v148, 0, v148
    v_min_f32 v149, 0, v149
    v_min_f32 v150, 0, v150
    v_min_f32 v151, 0, v151
    v_min_f32 v152, 0, v152
    v_min_f32 v153, 0, v153
    v_min_f32 v154, 0, v154
    v_min_f32 v155, 0, v155
    v_min_f32 v156, 0, v156
    v_min_f32 v157, 0, v157
    v_min_f32 v158, 0, v158
    v_min_f32 v159, 0, v159
    v_exp_f32 v144, v144
    v_exp_f32 v145, v145
    v_exp_f32 v146, v146
    v_exp_f32 v147, v147
    v_exp_f32 v148, v148
    v_exp_f32 v149, v149
    v_exp_f32 v150, v150
    v_exp_f32 v151, v151
    v_exp_f32 v152, v152
    v_exp_f32 v153, v153
    v_exp_f32 v154, v154
    v_exp_f32 v155, v155
    v_exp_f32 v156, v156
    v_exp_f32 v157, v157
    v_exp_f32 v158, v158
    v_exp_f32 v159, v159
    v_pk_add_f32 v[88:89], v[88:89], s[60:61]
    v_pk_add_f32 v[90:91], v[90:91], s[60:61]
    v_pk_add_f32 v[92:93], v[92:93], s[60:61]
    v_pk_add_f32 v[94:95], v[94:95], s[60:61]
    v_pk_add_f32 v[96:97], v[96:97], s[60:61]
    v_pk_add_f32 v[98:99], v[98:99], s[60:61]
    v_pk_add_f32 v[100:101], v[100:101], s[60:61]
    v_pk_add_f32 v[102:103], v[102:103], s[60:61]
    v_max_f32 v88, s60, v88
    v_max_f32 v89, s60, v89
    v_max_f32 v90, s60, v90
    v_max_f32 v91, s60, v91
    v_max_f32 v92, s60, v92
    v_max_f32 v93, s60, v93
    v_max_f32 v94, s60, v94
    v_max_f32 v95, s60, v95
    v_max_f32 v96, s60, v96
    v_max_f32 v97, s60, v97
    v_max_f32 v98, s60, v98
    v_max_f32 v99, s60, v99
    v_max_f32 v100, s60, v100
    v_max_f32 v101, s60, v101
    v_max_f32 v102, s60, v102
    v_max_f32 v103, s60, v103
    v_pk_add_f32 v[88:89], v[88:89], v[144:145]
    v_pk_add_f32 v[90:91], v[90:91], v[146:147]
    v_pk_add_f32 v[92:93], v[92:93], v[148:149]
    v_pk_add_f32 v[94:95], v[94:95], v[150:151]
    v_pk_add_f32 v[96:97], v[96:97], v[152:153]
    v_pk_add_f32 v[98:99], v[98:99], v[154:155]
    v_pk_add_f32 v[100:101], v[100:101], v[156:157]
    v_pk_add_f32 v[102:103], v[102:103], v[158:159]
    v_cvt_pk_bf16_f32 v88, v88, v89
    v_cvt_pk_bf16_f32 v89, v90, v91
    v_cvt_pk_bf16_f32 v90, v92, v93
    v_cvt_pk_bf16_f32 v91, v94, v95
    v_cvt_pk_bf16_f32 v96, v96, v97
    v_cvt_pk_bf16_f32 v97, v98, v99
    v_cvt_pk_bf16_f32 v98, v100, v101
    v_cvt_pk_bf16_f32 v99, v102, v103
    s_add_u32 s56, s55, 5120
    buffer_store_dwordx4 v[88:91], v137, s[32:35], s56 offen
    s_add_u32 s56, s55, 5760
    buffer_store_dwordx4 v[96:99], v137, s[32:35], s56 offen
    v_pk_mul_f32 v[144:145], v[104:105], s[58:59]
    v_pk_mul_f32 v[146:147], v[106:107], s[58:59]
    v_pk_mul_f32 v[148:149], v[108:109], s[58:59]
    v_pk_mul_f32 v[150:151], v[110:111], s[58:59]
    v_pk_mul_f32 v[152:153], v[112:113], s[58:59]
    v_pk_mul_f32 v[154:155], v[114:115], s[58:59]
    v_pk_mul_f32 v[156:157], v[116:117], s[58:59]
    v_pk_mul_f32 v[158:159], v[118:119], s[58:59]
    v_min_f32 v144, 0, v144
    v_min_f32 v145, 0, v145
    v_min_f32 v146, 0, v146
    v_min_f32 v147, 0, v147
    v_min_f32 v148, 0, v148
    v_min_f32 v149, 0, v149
    v_min_f32 v150, 0, v150
    v_min_f32 v151, 0, v151
    v_min_f32 v152, 0, v152
    v_min_f32 v153, 0, v153
    v_min_f32 v154, 0, v154
    v_min_f32 v155, 0, v155
    v_min_f32 v156, 0, v156
    v_min_f32 v157, 0, v157
    v_min_f32 v158, 0, v158
    v_min_f32 v159, 0, v159
    v_exp_f32 v144, v144
    v_exp_f32 v145, v145
    v_exp_f32 v146, v146
    v_exp_f32 v147, v147
    v_exp_f32 v148, v148
    v_exp_f32 v149, v149
    v_exp_f32 v150, v150
    v_exp_f32 v151, v151
    v_exp_f32 v152, v152
    v_exp_f32 v153, v153
    v_exp_f32 v154, v154
    v_exp_f32 v155, v155
    v_exp_f32 v156, v156
    v_exp_f32 v157, v157
    v_exp_f32 v158, v158
    v_exp_f32 v159, v159
    v_pk_add_f32 v[104:105], v[104:105], s[60:61]
    v_pk_add_f32 v[106:107], v[106:107], s[60:61]
    v_pk_add_f32 v[108:109], v[108:109], s[60:61]
    v_pk_add_f32 v[110:111], v[110:111], s[60:61]
    v_pk_add_f32 v[112:113], v[112:113], s[60:61]
    v_pk_add_f32 v[114:115], v[114:115], s[60:61]
    v_pk_add_f32 v[116:117], v[116:117], s[60:61]
    v_pk_add_f32 v[118:119], v[118:119], s[60:61]
    v_max_f32 v104, s60, v104
    v_max_f32 v105, s60, v105
    v_max_f32 v106, s60, v106
    v_max_f32 v107, s60, v107
    v_max_f32 v108, s60, v108
    v_max_f32 v109, s60, v109
    v_max_f32 v110, s60, v110
    v_max_f32 v111, s60, v111
    v_max_f32 v112, s60, v112
    v_max_f32 v113, s60, v113
    v_max_f32 v114, s60, v114
    v_max_f32 v115, s60, v115
    v_max_f32 v116, s60, v116
    v_max_f32 v117, s60, v117
    v_max_f32 v118, s60, v118
    v_max_f32 v119, s60, v119
    v_pk_add_f32 v[104:105], v[104:105], v[144:145]
    v_pk_add_f32 v[106:107], v[106:107], v[146:147]
    v_pk_add_f32 v[108:109], v[108:109], v[148:149]
    v_pk_add_f32 v[110:111], v[110:111], v[150:151]
    v_pk_add_f32 v[112:113], v[112:113], v[152:153]
    v_pk_add_f32 v[114:115], v[114:115], v[154:155]
    v_pk_add_f32 v[116:117], v[116:117], v[156:157]
    v_pk_add_f32 v[118:119], v[118:119], v[158:159]
    v_cvt_pk_bf16_f32 v104, v104, v105
    v_cvt_pk_bf16_f32 v105, v106, v107
    v_cvt_pk_bf16_f32 v106, v108, v109
    v_cvt_pk_bf16_f32 v107, v110, v111
    v_cvt_pk_bf16_f32 v112, v112, v113
    v_cvt_pk_bf16_f32 v113, v114, v115
    v_cvt_pk_bf16_f32 v114, v116, v117
    v_cvt_pk_bf16_f32 v115, v118, v119
    s_add_u32 s56, s55, 7680
    buffer_store_dwordx4 v[104:107], v136, s[32:35], s56 offen
    s_add_u32 s56, s55, 8320
    buffer_store_dwordx4 v[112:115], v136, s[32:35], s56 offen
    v_pk_mul_f32 v[144:145], v[120:121], s[58:59]
    v_pk_mul_f32 v[146:147], v[122:123], s[58:59]
    v_pk_mul_f32 v[148:149], v[124:125], s[58:59]
    v_pk_mul_f32 v[150:151], v[126:127], s[58:59]
    v_pk_mul_f32 v[152:153], v[128:129], s[58:59]
    v_pk_mul_f32 v[154:155], v[130:131], s[58:59]
    v_pk_mul_f32 v[156:157], v[132:133], s[58:59]
    v_pk_mul_f32 v[158:159], v[134:135], s[58:59]
    v_min_f32 v144, 0, v144
    v_min_f32 v145, 0, v145
    v_min_f32 v146, 0, v146
    v_min_f32 v147, 0, v147
    v_min_f32 v148, 0, v148
    v_min_f32 v149, 0, v149
    v_min_f32 v150, 0, v150
    v_min_f32 v151, 0, v151
    v_min_f32 v152, 0, v152
    v_min_f32 v153, 0, v153
    v_min_f32 v154, 0, v154
    v_min_f32 v155, 0, v155
    v_min_f32 v156, 0, v156
    v_min_f32 v157, 0, v157
    v_min_f32 v158, 0, v158
    v_min_f32 v159, 0, v159
    v_exp_f32 v144, v144
    v_exp_f32 v145, v145
    v_exp_f32 v146, v146
    v_exp_f32 v147, v147
    v_exp_f32 v148, v148
    v_exp_f32 v149, v149
    v_exp_f32 v150, v150
    v_exp_f32 v151, v151
    v_exp_f32 v152, v152
    v_exp_f32 v153, v153
    v_exp_f32 v154, v154
    v_exp_f32 v155, v155
    v_exp_f32 v156, v156
    v_exp_f32 v157, v157
    v_exp_f32 v158, v158
    v_exp_f32 v159, v159
    v_pk_add_f32 v[120:121], v[120:121], s[60:61]
    v_pk_add_f32 v[122:123], v[122:123], s[60:61]
    v_pk_add_f32 v[124:125], v[124:125], s[60:61]
    v_pk_add_f32 v[126:127], v[126:127], s[60:61]
    v_pk_add_f32 v[128:129], v[128:129], s[60:61]
    v_pk_add_f32 v[130:131], v[130:131], s[60:61]
    v_pk_add_f32 v[132:133], v[132:133], s[60:61]
    v_pk_add_f32 v[134:135], v[134:135], s[60:61]
    v_max_f32 v120, s60, v120
    v_max_f32 v121, s60, v121
    v_max_f32 v122, s60, v122
    v_max_f32 v123, s60, v123
    v_max_f32 v124, s60, v124
    v_max_f32 v125, s60, v125
    v_max_f32 v126, s60, v126
    v_max_f32 v127, s60, v127
    v_max_f32 v128, s60, v128
    v_max_f32 v129, s60, v129
    v_max_f32 v130, s60, v130
    v_max_f32 v131, s60, v131
    v_max_f32 v132, s60, v132
    v_max_f32 v133, s60, v133
    v_max_f32 v134, s60, v134
    v_max_f32 v135, s60, v135
    v_pk_add_f32 v[120:121], v[120:121], v[144:145]
    v_pk_add_f32 v[122:123], v[122:123], v[146:147]
    v_pk_add_f32 v[124:125], v[124:125], v[148:149]
    v_pk_add_f32 v[126:127], v[126:127], v[150:151]
    v_pk_add_f32 v[128:129], v[128:129], v[152:153]
    v_pk_add_f32 v[130:131], v[130:131], v[154:155]
    v_pk_add_f32 v[132:133], v[132:133], v[156:157]
    v_pk_add_f32 v[134:135], v[134:135], v[158:159]
    v_cvt_pk_bf16_f32 v120, v120, v121
    v_cvt_pk_bf16_f32 v121, v122, v123
    v_cvt_pk_bf16_f32 v122, v124, v125
    v_cvt_pk_bf16_f32 v123, v126, v127
    v_cvt_pk_bf16_f32 v128, v128, v129
    v_cvt_pk_bf16_f32 v129, v130, v131
    v_cvt_pk_bf16_f32 v130, v132, v133
    v_cvt_pk_bf16_f32 v131, v134, v135
    s_add_u32 s56, s55, 7680
    buffer_store_dwordx4 v[120:123], v137, s[32:35], s56 offen
    s_add_u32 s56, s55, 8320
    buffer_store_dwordx4 v[128:131], v137, s[32:35], s56 offen
    s_endpgm
K1_loader:
    s_setprio 3
    s_sub_u32 s50, s48, 4
    s_lshr_b32 s56, s50, 1
    s_and_b32 s57, s50, 1
    v_lshrrev_b32 v1, 4, v0
    v_and_b32 v3, 7, v0
    v_xor_b32 v2, v1, v3
    v_add_u32 v4, 4, v1
    v_xor_b32 v4, v4, v3
    v_lshrrev_b32 v3, 3, v0
    s_lshl_b32 s51, s57, 7
    v_add_u32 v3, s51, v3
    v_mul_u32_u24 v3, 1280, v3
    v_lshl_add_u32 v16, v2, 4, v3
    v_lshl_add_u32 v17, v4, 4, v3
    v_add_u32 v17, 10240, v17
    s_mul_i32 s52, s44, 256*1280
    s_lshl_b32 s51, s56, 7
    s_add_u32 s52, s52, s51
    s_lshl_b32 s53, s57, 14
    s_lshl_b32 s51, s57, 5
    v_add_u32 v2, s51, v1
    v_mul_u32_u24 v2, 3840, v2
    v_lshlrev_b32 v3, 2, v1
    v_and_b32 v4, 15, v0
    v_xor_b32 v3, v3, v4
    v_lshl_add_u32 v2, v3, 4, v2
    s_mul_i32 s51, s47, 1280
    s_lshl_b32 s54, s49, 1
    s_add_u32 s51, s51, s54
    v_add_u32 v12, s51, v2
    s_lshl_b32 s54, s57, 13
    s_add_u32 s54, s54, 32768
    s_mul_i32 s55, s56, 245760
    v_mov_b32 v4, s50
    v_lshlrev_b32 v4, 2, v4
    v_add_u32 v4, 147456, v4
    v_mov_b32 v5, 147472
    v_mov_b32 v6, 1
    s_lshl_b32 s67, s56, 2
    s_mul_i32 s58, s56, 49152
    s_mov_b32 s59, s56
K1_ld_l:
    s_cmp_lt_u32 s59, 3
    s_cbranch_scc1 K1_ld_go
    s_mul_i32 s60, s59, 43
    s_lshr_b32 s60, s60, 7
    s_lshl_b32 s60, s60, 2
    v_add_u32 v8, s67, v5
K1_ld_sp:
    ds_read_b32 v7, v8
    s_waitcnt lgkmcnt(0)
    v_readfirstlane_b32 s62, v7
    s_nop 3
    s_cmp_ge_u32 s62, s60
    s_cbranch_scc1 K1_ld_go
    s_sleep 1
    s_branch K1_ld_sp
K1_ld_go:
    s_cmp_lg_u32 s59, 1
    s_cbranch_scc1 K1_ld_go2
    s_barrier
K1_ld_go2:
    s_add_u32 s60, s54, s58
    s_mov_b32 s61, s55
    s_add_u32 m0, s60, 0
    s_add_u32 s61, s55, 0
    buffer_load_dwordx4 v12, s[28:31], s61 offen lds
    s_add_u32 m0, s60, 1024
    s_add_u32 s61, s55, 15360
    buffer_load_dwordx4 v12, s[28:31], s61 offen lds
    s_add_u32 m0, s60, 2048
    s_add_u32 s61, s55, 30720
    buffer_load_dwordx4 v12, s[28:31], s61 offen lds
    s_add_u32 m0, s60, 3072
    s_add_u32 s61, s55, 46080
    buffer_load_dwordx4 v12, s[28:31], s61 offen lds
    s_add_u32 m0, s60, 4096
    s_add_u32 s61, s55, 61440
    buffer_load_dwordx4 v12, s[28:31], s61 offen lds
    s_add_u32 m0, s60, 5120
    s_add_u32 s61, s55, 76800
    buffer_load_dwordx4 v12, s[28:31], s61 offen lds
    s_add_u32 m0, s60, 6144
    s_add_u32 s61, s55, 92160
    buffer_load_dwordx4 v12, s[28:31], s61 offen lds
    s_add_u32 m0, s60, 7168
    s_add_u32 s61, s55, 107520
    buffer_load_dwordx4 v12, s[28:31], s61 offen lds
    s_add_u32 s60, s53, s58
    s_add_u32 m0, s60, 0
    s_add_u32 s61, s52, 0
    buffer_load_dwordx4 v16, s[24:27], s61 offen lds
    s_add_u32 m0, s60, 1024
    s_add_u32 s61, s52, 0
    buffer_load_dwordx4 v17, s[24:27], s61 offen lds
    s_add_u32 m0, s60, 2048
    s_add_u32 s61, s52, 20480
    buffer_load_dwordx4 v16, s[24:27], s61 offen lds
    s_add_u32 m0, s60, 3072
    s_add_u32 s61, s52, 20480
    buffer_load_dwordx4 v17, s[24:27], s61 offen lds
    s_add_u32 m0, s60, 4096
    s_add_u32 s61, s52, 40960
    buffer_load_dwordx4 v16, s[24:27], s61 offen lds
    s_add_u32 m0, s60, 5120
    s_add_u32 s61, s52, 40960
    buffer_load_dwordx4 v17, s[24:27], s61 offen lds
    s_add_u32 m0, s60, 6144
    s_add_u32 s61, s52, 61440
    buffer_load_dwordx4 v16, s[24:27], s61 offen lds
    s_add_u32 m0, s60, 7168
    s_add_u32 s61, s52, 61440
    buffer_load_dwordx4 v17, s[24:27], s61 offen lds
    s_add_u32 m0, s60, 8192
    s_add_u32 s61, s52, 81920
    buffer_load_dwordx4 v16, s[24:27], s61 offen lds
    s_add_u32 m0, s60, 9216
    s_add_u32 s61, s52, 81920
    buffer_load_dwordx4 v17, s[24:27], s61 offen lds
    s_add_u32 m0, s60, 10240
    s_add_u32 s61, s52, 102400
    buffer_load_dwordx4 v16, s[24:27], s61 offen lds
    s_add_u32 m0, s60, 11264
    s_add_u32 s61, s52, 102400
    buffer_load_dwordx4 v17, s[24:27], s61 offen lds
    s_add_u32 m0, s60, 12288
    s_add_u32 s61, s52, 122880
    buffer_load_dwordx4 v16, s[24:27], s61 offen lds
    s_add_u32 m0, s60, 13312
    s_add_u32 s61, s52, 122880
    buffer_load_dwordx4 v17, s[24:27], s61 offen lds
    s_add_u32 m0, s60, 14336
    s_add_u32 s61, s52, 143360
    buffer_load_dwordx4 v16, s[24:27], s61 offen lds
    s_add_u32 m0, s60, 15360
    s_add_u32 s61, s52, 143360
    buffer_load_dwordx4 v17, s[24:27], s61 offen lds
    s_cmp_lg_u32 s59, 0
    s_cbranch_scc1 K1_ld_sig2
    s_barrier
K1_ld_sig2:
    s_waitcnt vmcnt(0)
    s_mov_b64 exec, 1
    ds_add_u32 v4, v6
    s_mov_b64 exec, -1
    s_add_u32 s55, s55, 491520
    s_add_u32 s52, s52, 256
    s_add_u32 s58, s58, 98304
    s_cmp_ge_u32 s58, 147456
    s_cselect_b32 s60, 147456, 0
    s_sub_u32 s58, s58, s60
    s_add_u32 s67, s67, 8
    s_cmp_ge_u32 s67, 12
    s_cselect_b32 s60, 12, 0
    s_sub_u32 s67, s67, s60
    s_add_u32 s59, s59, 2
    s_cmp_lt_u32 s59, 10
    s_cbranch_scc1 K1_ld_l
    s_endpgm
K1_side:
    s_mov_b32 s36, s16
    s_and_b32 s37, s17, 0xffff
    s_mov_b32 s38, 1280
    s_mov_b32 s39, 0x00020000
    s_sub_u32 s50, s2, 240
    s_cmp_ge_u32 s48, 4
    s_cbranch_scc1 K1_repack
    s_lshl_b32 s51, s50, 7
    s_lshl_b32 s52, s48, 5
    s_add_u32 s51, s51, s52
    v_lshrrev_b32 v1, 4, v0
    v_and_b32 v2, 15, v0
    v_lshlrev_b32 v2, 4, v2
    v_add_u32 v3, s51, v1
    v_mul_u32_u24 v4, 1280, v3
    v_add_u32 v4, v4, v2
    v_lshlrev_b32 v3, 2, v3
    v_and_b32 v5, 15, v0
    v_cmp_eq_u32 vcc, 0, v5
    v_mov_b32 v5, 0x80000000
    s_nop 0
    v_cndmask_b32 v3, v5, v3, vcc
    buffer_load_dwordx4 v[8:11], v2, s[36:39], 0 offen offset:0
    buffer_load_dwordx4 v[12:15], v2, s[36:39], 0 offen offset:256
    buffer_load_dwordx4 v[16:19], v2, s[36:39], 0 offen offset:512
    buffer_load_dwordx4 v[20:23], v2, s[36:39], 0 offen offset:768
    buffer_load_dwordx4 v[24:27], v2, s[36:39], 0 offen offset:1024
    s_mov_b32 s58, 3216550459
    s_mov_b32 s59, 22020096
    s_mov_b32 s52, 0
    s_mov_b32 s53, 8
K1_gate_l:
    buffer_load_dwordx4 v[28:31], v4, s[24:27], s52 offen offset:0
    buffer_load_dwordx4 v[32:35], v4, s[24:27], s52 offen offset:256
    buffer_load_dwordx4 v[36:39], v4, s[24:27], s52 offen offset:512
    buffer_load_dwordx4 v[40:43], v4, s[24:27], s52 offen offset:768
    buffer_load_dwordx4 v[44:47], v4, s[24:27], s52 offen offset:1024
    v_mov_b32 v6, 0
    s_waitcnt vmcnt(0)
    v_dot2_f32_bf16 v6, v28, v8, v6
    v_dot2_f32_bf16 v6, v29, v9, v6
    v_dot2_f32_bf16 v6, v30, v10, v6
    v_dot2_f32_bf16 v6, v31, v11, v6
    v_dot2_f32_bf16 v6, v32, v12, v6
    v_dot2_f32_bf16 v6, v33, v13, v6
    v_dot2_f32_bf16 v6, v34, v14, v6
    v_dot2_f32_bf16 v6, v35, v15, v6
    v_dot2_f32_bf16 v6, v36, v16, v6
    v_dot2_f32_bf16 v6, v37, v17, v6
    v_dot2_f32_bf16 v6, v38, v18, v6
    v_dot2_f32_bf16 v6, v39, v19, v6
    v_dot2_f32_bf16 v6, v40, v20, v6
    v_dot2_f32_bf16 v6, v41, v21, v6
    v_dot2_f32_bf16 v6, v42, v22, v6
    v_dot2_f32_bf16 v6, v43, v23, v6
    v_dot2_f32_bf16 v6, v44, v24, v6
    v_dot2_f32_bf16 v6, v45, v25, v6
    v_dot2_f32_bf16 v6, v46, v26, v6
    v_dot2_f32_bf16 v6, v47, v27, v6
    s_nop 3
    v_add_f32_dpp v6, v6, v6 row_ror:8 row_mask:0xf bank_mask:0xf
    s_nop 1
    v_add_f32_dpp v6, v6, v6 row_ror:4 row_mask:0xf bank_mask:0xf
    s_nop 1
    v_add_f32_dpp v6, v6, v6 row_ror:2 row_mask:0xf bank_mask:0xf
    s_nop 1
    v_add_f32_dpp v6, v6, v6 row_ror:1 row_mask:0xf bank_mask:0xf
    s_nop 1
    v_mul_f32 v6, s58, v6
    v_exp_f32 v6, v6
    s_nop 0
    v_add_f32 v6, 1.0, v6
    v_rcp_f32 v6, v6
    s_nop 0
    buffer_store_dword v6, v3, s[32:35], s59 offen
    s_add_u32 s52, s52, 5120
    s_add_u32 s59, s59, 16
    s_sub_u32 s53, s53, 1
    s_cmp_lg_u32 s53, 0
    s_cbranch_scc1 K1_gate_l
    s_endpgm
K1_repack:
    s_sub_u32 s51, s48, 4
    s_lshl_b32 s52, s50, 2
    s_add_u32 s52, s52, s51
    s_lshl_b32 s53, s51, 13
    v_lshrrev_b32 v1, 4, v0
    v_and_b32 v4, 15, v0
    v_mul_u32_u24 v2, 1280, v1
    v_lshlrev_b32 v3, 1, v1
    v_xor_b32 v3, v3, v4
    v_lshl_add_u32 v8, v3, 4, v2
    v_add_u32 v3, 4, v1
    v_lshlrev_b32 v3, 1, v3
    v_xor_b32 v3, v3, v4
    v_lshl_add_u32 v9, v3, 4, v2
    v_lshrrev_b32 v2, 4, v0
    v_bfe_u32 v3, v0, 2, 2
    v_lshl_add_u32 v4, v2, 3, v3
    v_lshlrev_b32 v4, 8, v4
    v_and_b32 v5, 1, v2
    v_lshl_add_u32 v5, v5, 2, v3
    v_lshl_add_u32 v4, v5, 5, v4
    v_and_b32 v5, 3, v0
    v_lshl_add_u32 v4, v5, 3, v4
    v_add_u32 v4, s53, v4
    v_lshlrev_b32 v10, 4, v0
    v_subrev_u32 v4, s53, v4
    v_xor_b32 v16, 0, v4
    v_add_u32 v16, s53, v16
    v_xor_b32 v17, 32, v4
    v_add_u32 v17, s53, v17
    v_xor_b32 v18, 64, v4
    v_add_u32 v18, s53, v18
    v_xor_b32 v19, 96, v4
    v_add_u32 v19, s53, v19
    v_xor_b32 v20, 128, v4
    v_add_u32 v20, s53, v20
    v_xor_b32 v21, 160, v4
    v_add_u32 v21, s53, v21
    v_xor_b32 v22, 192, v4
    v_add_u32 v22, s53, v22
    v_xor_b32 v23, 224, v4
    v_add_u32 v23, s53, v23
K1_rp_l:
    s_cmp_ge_u32 s52, 200
    s_cbranch_scc1 K1_done
    s_cmp_ge_u32 s52, 100
    s_cselect_b32 s54, 1, 0
    s_mul_i32 s55, s54, 100
    s_sub_u32 s55, s52, s55
    s_mul_i32 s56, s55, 205
    s_lshr_b32 s56, s56, 10
    s_mul_i32 s57, s56, 5
    s_sub_u32 s57, s55, s57
    s_cmp_eq_u32 s54, 0
    s_cselect_b32 s36, s8, s14
    s_cselect_b32 s37, s9, s15
    s_mov_b32 s40, s36
    s_and_b32 s41, s37, 0xffff
    s_mov_b32 s42, 819200
    s_mov_b32 s43, 0x00020000
    s_mul_i32 s58, s56, 32*1280
    s_lshl_b32 s59, s57, 8
    s_add_u32 s58, s58, s59
    s_add_u32 m0, s53, 0
    s_add_u32 s59, s58, 0
    buffer_load_dwordx4 v8, s[40:43], s59 offen lds
    s_add_u32 m0, s53, 1024
    s_add_u32 s59, s58, 5120
    buffer_load_dwordx4 v8, s[40:43], s59 offen lds
    s_add_u32 m0, s53, 2048
    s_add_u32 s59, s58, 10240
    buffer_load_dwordx4 v9, s[40:43], s59 offen lds
    s_add_u32 m0, s53, 3072
    s_add_u32 s59, s58, 15360
    buffer_load_dwordx4 v9, s[40:43], s59 offen lds
    s_add_u32 m0, s53, 4096
    s_add_u32 s59, s58, 20480
    buffer_load_dwordx4 v8, s[40:43], s59 offen lds
    s_add_u32 m0, s53, 5120
    s_add_u32 s59, s58, 25600
    buffer_load_dwordx4 v8, s[40:43], s59 offen lds
    s_add_u32 m0, s53, 6144
    s_add_u32 s59, s58, 30720
    buffer_load_dwordx4 v9, s[40:43], s59 offen lds
    s_add_u32 m0, s53, 7168
    s_add_u32 s59, s58, 35840
    buffer_load_dwordx4 v9, s[40:43], s59 offen lds
    s_waitcnt vmcnt(0)
    ds_read_b64_tr_b16 v[32:33], v16 offset:0
    ds_read_b64_tr_b16 v[34:35], v16 offset:1024
    ds_read_b64_tr_b16 v[36:37], v17 offset:0
    ds_read_b64_tr_b16 v[38:39], v17 offset:1024
    ds_read_b64_tr_b16 v[40:41], v18 offset:0
    ds_read_b64_tr_b16 v[42:43], v18 offset:1024
    ds_read_b64_tr_b16 v[44:45], v19 offset:0
    ds_read_b64_tr_b16 v[46:47], v19 offset:1024
    ds_read_b64_tr_b16 v[48:49], v20 offset:0
    ds_read_b64_tr_b16 v[50:51], v20 offset:1024
    ds_read_b64_tr_b16 v[52:53], v21 offset:0
    ds_read_b64_tr_b16 v[54:55], v21 offset:1024
    ds_read_b64_tr_b16 v[56:57], v22 offset:0
    ds_read_b64_tr_b16 v[58:59], v22 offset:1024
    ds_read_b64_tr_b16 v[60:61], v23 offset:0
    ds_read_b64_tr_b16 v[62:63], v23 offset:1024
    s_waitcnt lgkmcnt(0)
    s_lshl_b32 s59, s57, 3
    s_add_u32 s59, s59, 0
    s_mul_i32 s60, s59, 205
    s_lshr_b32 s60, s60, 10
    s_mul_i32 s61, s60, 5
    s_sub_u32 s61, s59, s61
    s_lshl_b32 s62, s54, 3
    s_add_u32 s62, s62, s60
    s_mul_i32 s62, s62, 20
    s_add_u32 s62, s62, s56
    s_mul_i32 s62, s62, 5
    s_add_u32 s62, s62, s61
    s_lshl_b32 s62, s62, 10
    s_add_u32 s62, s62, 22028288
    buffer_store_dwordx4 v[32:35], v10, s[32:35], s62 offen
    s_lshl_b32 s59, s57, 3
    s_add_u32 s59, s59, 1
    s_mul_i32 s60, s59, 205
    s_lshr_b32 s60, s60, 10
    s_mul_i32 s61, s60, 5
    s_sub_u32 s61, s59, s61
    s_lshl_b32 s62, s54, 3
    s_add_u32 s62, s62, s60
    s_mul_i32 s62, s62, 20
    s_add_u32 s62, s62, s56
    s_mul_i32 s62, s62, 5
    s_add_u32 s62, s62, s61
    s_lshl_b32 s62, s62, 10
    s_add_u32 s62, s62, 22028288
    buffer_store_dwordx4 v[36:39], v10, s[32:35], s62 offen
    s_lshl_b32 s59, s57, 3
    s_add_u32 s59, s59, 2
    s_mul_i32 s60, s59, 205
    s_lshr_b32 s60, s60, 10
    s_mul_i32 s61, s60, 5
    s_sub_u32 s61, s59, s61
    s_lshl_b32 s62, s54, 3
    s_add_u32 s62, s62, s60
    s_mul_i32 s62, s62, 20
    s_add_u32 s62, s62, s56
    s_mul_i32 s62, s62, 5
    s_add_u32 s62, s62, s61
    s_lshl_b32 s62, s62, 10
    s_add_u32 s62, s62, 22028288
    buffer_store_dwordx4 v[40:43], v10, s[32:35], s62 offen
    s_lshl_b32 s59, s57, 3
    s_add_u32 s59, s59, 3
    s_mul_i32 s60, s59, 205
    s_lshr_b32 s60, s60, 10
    s_mul_i32 s61, s60, 5
    s_sub_u32 s61, s59, s61
    s_lshl_b32 s62, s54, 3
    s_add_u32 s62, s62, s60
    s_mul_i32 s62, s62, 20
    s_add_u32 s62, s62, s56
    s_mul_i32 s62, s62, 5
    s_add_u32 s62, s62, s61
    s_lshl_b32 s62, s62, 10
    s_add_u32 s62, s62, 22028288
    buffer_store_dwordx4 v[44:47], v10, s[32:35], s62 offen
    s_lshl_b32 s59, s57, 3
    s_add_u32 s59, s59, 4
    s_mul_i32 s60, s59, 205
    s_lshr_b32 s60, s60, 10
    s_mul_i32 s61, s60, 5
    s_sub_u32 s61, s59, s61
    s_lshl_b32 s62, s54, 3
    s_add_u32 s62, s62, s60
    s_mul_i32 s62, s62, 20
    s_add_u32 s62, s62, s56
    s_mul_i32 s62, s62, 5
    s_add_u32 s62, s62, s61
    s_lshl_b32 s62, s62, 10
    s_add_u32 s62, s62, 22028288
    buffer_store_dwordx4 v[48:51], v10, s[32:35], s62 offen
    s_lshl_b32 s59, s57, 3
    s_add_u32 s59, s59, 5
    s_mul_i32 s60, s59, 205
    s_lshr_b32 s60, s60, 10
    s_mul_i32 s61, s60, 5
    s_sub_u32 s61, s59, s61
    s_lshl_b32 s62, s54, 3
    s_add_u32 s62, s62, s60
    s_mul_i32 s62, s62, 20
    s_add_u32 s62, s62, s56
    s_mul_i32 s62, s62, 5
    s_add_u32 s62, s62, s61
    s_lshl_b32 s62, s62, 10
    s_add_u32 s62, s62, 22028288
    buffer_store_dwordx4 v[52:55], v10, s[32:35], s62 offen
    s_lshl_b32 s59, s57, 3
    s_add_u32 s59, s59, 6
    s_mul_i32 s60, s59, 205
    s_lshr_b32 s60, s60, 10
    s_mul_i32 s61, s60, 5
    s_sub_u32 s61, s59, s61
    s_lshl_b32 s62, s54, 3
    s_add_u32 s62, s62, s60
    s_mul_i32 s62, s62, 20
    s_add_u32 s62, s62, s56
    s_mul_i32 s62, s62, 5
    s_add_u32 s62, s62, s61
    s_lshl_b32 s62, s62, 10
    s_add_u32 s62, s62, 22028288
    buffer_store_dwordx4 v[56:59], v10, s[32:35], s62 offen
    s_lshl_b32 s59, s57, 3
    s_add_u32 s59, s59, 7
    s_mul_i32 s60, s59, 205
    s_lshr_b32 s60, s60, 10
    s_mul_i32 s61, s60, 5
    s_sub_u32 s61, s59, s61
    s_lshl_b32 s62, s54, 3
    s_add_u32 s62, s62, s60
    s_mul_i32 s62, s62, 20
    s_add_u32 s62, s62, s56
    s_mul_i32 s62, s62, 5
    s_add_u32 s62, s62, s61
    s_lshl_b32 s62, s62, 10
    s_add_u32 s62, s62, 22028288
    buffer_store_dwordx4 v[60:63], v10, s[32:35], s62 offen
    s_waitcnt vmcnt(0)
    s_add_u32 s52, s52, 64
    s_branch K1_rp_l
K1_done:
    s_endpgm
.globl attn_kernel
.p2align 8
.type attn_kernel,@function
attn_kernel:
    s_cmp_ge_u32 s2, 256
    s_cbranch_scc1 K2_done
    s_load_dwordx4 s[20:23], s[0:1], 64
    s_and_b32 s40, s2, 31
    s_lshr_b32 s41, s2, 5
    v_lshrrev_b32 v1, 6, v0
    v_and_b32 v0, 63, v0
    s_nop 0
    v_readfirstlane_b32 s48, v1
    v_and_b32 v1, 31, v0
    v_lshrrev_b32 v2, 5, v0
    s_waitcnt lgkmcnt(0)
    s_mov_b32 s32, s22
    s_and_b32 s33, s23, 0xffff
    s_mov_b32 s34, 28909568
    s_mov_b32 s35, 0x00020000
    s_cmp_ge_u32 s48, 8
    s_cbranch_scc1 K2_help
    s_lshl_b32 s42, s41, 8
    s_lshl_b32 s43, s48, 5
    s_add_u32 s42, s42, s43
    v_add_u32 v3, s42, v1
    s_mul_i32 s44, s40, 81920
    s_mul_i32 s43, s42, 40
    s_add_u32 s44, s44, s43
    s_add_u32 s44, s44, 0
    v_lshlrev_b32 v4, 3, v1
    v_lshl_add_u32 v5, v2, 9, v4
    v_add_u32 v6, 1024, v4
    v_cmp_eq_u32 vcc, 0, v2
    v_mov_b32 v7, 0x80000000
    v_cndmask_b32 v6, v7, v6, vcc
    buffer_load_dwordx2 v[88:89], v5, s[32:35], s44 offen
    buffer_load_dwordx2 v[90:91], v5, s[32:35], s44 offen offset:256
    buffer_load_dwordx2 v[92:93], v6, s[32:35], s44 offen
    v_lshlrev_b32 v5, 2, v3
    s_mov_b32 s44, 22020096
    buffer_load_dword v11, v5, s[32:35], s44 offen
    v_and_b32 v5, 63, v3
    v_lshlrev_b32 v5, 3, v5
    v_lshl_add_u32 v14, v2, 9, v5
    v_add_u32 v15, 2048, v5
    s_lshr_b32 s62, s42, 6
    s_mul_i32 s62, s62, 163840
    v_cndmask_b32 v15, v7, v15, vcc
    s_mul_i32 s43, s40, 2560
    s_add_u32 s62, s62, s43
    s_add_u32 s62, s62, 23666688
    v_cmp_eq_u32 vcc, 20, v1
    v_mov_b32 v5, 0
    v_mov_b32 v7, 0x3f803f80
    s_mov_b32 s46, 0x000fffff
    v_cndmask_b32 v5, v5, v7, vcc
    s_mov_b32 s47, 0x000fffff
    v_mov_b32 v112, v5
    v_mov_b32 v113, v5
    v_mov_b32 v114, v5
    v_mov_b32 v115, v5
    v_mov_b32 v116, v5
    v_mov_b32 v117, v5
    v_mov_b32 v118, v5
    v_mov_b32 v119, v5
    v_mov_b32 v120, v5
    v_mov_b32 v121, v5
    v_mov_b32 v122, v5
    v_mov_b32 v123, v5
    v_mov_b32 v124, v5
    v_mov_b32 v125, v5
    v_mov_b32 v126, v5
    v_mov_b32 v127, v5
    s_mov_b32 s50, 0
    s_waitcnt vmcnt(0)
    s_barrier
    v_lshlrev_b32 v8, 4, v1
    v_lshl_add_u32 v8, v2, 9, v8
    v_lshlrev_b32 v9, 3, v1
    v_add_u32 v9, 1024, v9
    v_lshlrev_b32 v10, 4, v1
    v_mul_u32_u24 v5, 320, v2
    v_add_u32 v10, v10, v5
    v_add_u32 v10, 1280, v10
    ds_read_b128 v[96:99], v8 offset:0
    ds_read_b64 v[100:101], v9 offset:0
    s_waitcnt lgkmcnt(0)
    v_mfma_f32_32x32x16_bf16 v[16:31], v[96:99], v[88:91], 0
    v_mfma_f32_32x32x8_bf16 v[16:31], v[100:101], v[92:93], v[16:31]
    s_nop 7
    s_nop 7
    v_max3_f32 v5, v16, v17, v18
    v_max3_f32 v5, v5, v19, v20
    v_max3_f32 v5, v5, v21, v22
    v_max3_f32 v5, v5, v23, v24
    v_max3_f32 v5, v5, v25, v26
    v_max3_f32 v5, v5, v27, v28
    v_max3_f32 v5, v5, v29, v30
    v_max_f32 v5, v5, v31
    v_mov_b32 v6, v5
    s_nop 1
    v_permlane32_swap_b32 v5, v6
    v_max_f32 v5, v5, v6
K2_main:
    v_sub_f32 v64, 0, v5
    v_sub_f32 v65, 0, v5
    v_sub_f32 v66, 0, v5
    v_sub_f32 v67, 0, v5
    v_sub_f32 v68, 0, v5
    v_sub_f32 v69, 0, v5
    v_sub_f32 v70, 0, v5
    v_sub_f32 v71, 0, v5
    v_sub_f32 v72, 0, v5
    v_sub_f32 v73, 0, v5
    v_sub_f32 v74, 0, v5
    v_sub_f32 v75, 0, v5
    v_sub_f32 v76, 0, v5
    v_sub_f32 v77, 0, v5
    v_sub_f32 v78, 0, v5
    v_sub_f32 v79, 0, v5
    v_mov_b32 v48, 0
    v_mov_b32 v49, 0
    v_mov_b32 v50, 0
    v_mov_b32 v51, 0
    v_mov_b32 v52, 0
    v_mov_b32 v53, 0
    v_mov_b32 v54, 0
    v_mov_b32 v55, 0
    v_mov_b32 v56, 0
    v_mov_b32 v57, 0
    v_mov_b32 v58, 0
    v_mov_b32 v59, 0
    v_mov_b32 v60, 0
    v_mov_b32 v61, 0
    v_mov_b32 v62, 0
    v_mov_b32 v63, 0
    v_lshlrev_b32 v8, 4, v1
    v_lshl_add_u32 v8, v2, 9, v8
    v_lshlrev_b32 v9, 3, v1
    v_add_u32 v9, 1024, v9
    v_lshlrev_b32 v10, 4, v1
    v_mul_u32_u24 v5, 320, v2
    v_add_u32 v10, v10, v5
    v_add_u32 v10, 1280, v10
    ds_read_b128 v[96:99], v8 offset:0
    ds_read_b64 v[100:101], v9 offset:0
    s_waitcnt lgkmcnt(0)
    v_mfma_f32_32x32x16_bf16 v[16:31], v[96:99], v[88:91], v[64:79]
    v_mfma_f32_32x32x8_bf16 v[16:31], v[100:101], v[92:93], v[16:31]
    ds_read_b128 v[104:107], v8 offset:2560
    ds_read_b64 v[108:109], v9 offset:2560
    s_mov_b64 exec, s[46:47]
    ds_read_b128 v[112:115], v10 offset:0
    ds_read_b128 v[116:119], v10 offset:640
    s_mov_b64 exec, -1
    s_nop 7
    s_nop 7
    s_mov_b32 s51, 0
    v_mov_b32 v84, 0
    v_mov_b32 v85, 0
    v_mov_b32 v86, 0
    v_mov_b32 v87, 0
    v_mov_b32 v140, 0
    v_mov_b32 v141, 0
    v_mov_b32 v142, 0
    v_mov_b32 v143, 0
K2_loop:
    s_cmp_lg_u32 s50, 0
    s_cbranch_scc1 K2_nosync
    s_and_b32 s52, s51, 3
    s_cmp_eq_u32 s52, 1
    s_cbranch_scc0 K2_nosync
    s_barrier
K2_nosync:
    s_waitcnt lgkmcnt(2)
    v_mfma_f32_32x32x16_bf16 v[32:47], v[104:107], v[88:91], v[64:79]
    v_exp_f32 v128, v16
    v_exp_f32 v129, v17
    v_exp_f32 v130, v18
    v_exp_f32 v131, v19
    v_cvt_pk_bf16_f32 v86, v140, v141
    v_cvt_pk_bf16_f32 v87, v142, v143
    v_mfma_f32_32x32x8_bf16 v[32:47], v[108:109], v[92:93], v[32:47]
    ds_read_b128 v[96:99], v8 offset:5120
    ds_read_b64 v[100:101], v9 offset:5120
    v_exp_f32 v132, v20
    v_exp_f32 v133, v21
    v_exp_f32 v134, v22
    v_exp_f32 v135, v23
    v_cvt_pk_bf16_f32 v80, v128, v129
    v_cvt_pk_bf16_f32 v81, v130, v131
    v_mfma_f32_32x32x16_bf16 v[48:63], v[124:127], v[84:87], v[48:63]
    v_exp_f32 v136, v24
    v_exp_f32 v137, v25
    v_cvt_pk_bf16_f32 v82, v132, v133
    v_cvt_pk_bf16_f32 v83, v134, v135
    v_exp_f32 v138, v26
    v_exp_f32 v139, v27
    s_waitcnt lgkmcnt(2)
    v_mfma_f32_32x32x16_bf16 v[48:63], v[112:115], v[80:83], v[48:63]
    s_mov_b64 exec, s[46:47]
    ds_read_b128 v[120:123], v10 offset:2560
    ds_read_b128 v[124:127], v10 offset:3200
    s_mov_b64 exec, -1
    v_exp_f32 v140, v28
    v_exp_f32 v141, v29
    v_exp_f32 v142, v30
    v_exp_f32 v143, v31
    v_cvt_pk_bf16_f32 v84, v136, v137
    v_cvt_pk_bf16_f32 v85, v138, v139
    s_waitcnt lgkmcnt(2)
    v_mfma_f32_32x32x16_bf16 v[16:31], v[96:99], v[88:91], v[64:79]
    v_exp_f32 v128, v32
    v_exp_f32 v129, v33
    v_exp_f32 v130, v34
    v_exp_f32 v131, v35
    v_cvt_pk_bf16_f32 v86, v140, v141
    v_cvt_pk_bf16_f32 v87, v142, v143
    v_mfma_f32_32x32x8_bf16 v[16:31], v[100:101], v[92:93], v[16:31]
    ds_read_b128 v[104:107], v8 offset:7680
    ds_read_b64 v[108:109], v9 offset:7680
    v_exp_f32 v132, v36
    v_exp_f32 v133, v37
    v_exp_f32 v134, v38
    v_exp_f32 v135, v39
    v_cvt_pk_bf16_f32 v80, v128, v129
    v_cvt_pk_bf16_f32 v81, v130, v131
    v_mfma_f32_32x32x16_bf16 v[48:63], v[116:119], v[84:87], v[48:63]
    v_exp_f32 v136, v40
    v_exp_f32 v137, v41
    v_cvt_pk_bf16_f32 v82, v132, v133
    v_cvt_pk_bf16_f32 v83, v134, v135
    v_exp_f32 v138, v42
    v_exp_f32 v139, v43
    s_waitcnt lgkmcnt(2)
    v_mfma_f32_32x32x16_bf16 v[48:63], v[120:123], v[80:83], v[48:63]
    s_mov_b64 exec, s[46:47]
    ds_read_b128 v[112:115], v10 offset:5120
    ds_read_b128 v[116:119], v10 offset:5760
    s_mov_b64 exec, -1
    v_exp_f32 v140, v44
    v_exp_f32 v141, v45
    v_exp_f32 v142, v46
    v_exp_f32 v143, v47
    v_cvt_pk_bf16_f32 v84, v136, v137
    v_cvt_pk_bf16_f32 v85, v138, v139
    s_waitcnt lgkmcnt(2)
    v_mfma_f32_32x32x16_bf16 v[32:47], v[104:107], v[88:91], v[64:79]
    v_exp_f32 v128, v16
    v_exp_f32 v129, v17
    v_exp_f32 v130, v18
    v_exp_f32 v131, v19
    v_cvt_pk_bf16_f32 v86, v140, v141
    v_cvt_pk_bf16_f32 v87, v142, v143
    v_mfma_f32_32x32x8_bf16 v[32:47], v[108:109], v[92:93], v[32:47]
    ds_read_b128 v[96:99], v8 offset:10240
    ds_read_b64 v[100:101], v9 offset:10240
    v_exp_f32 v132, v20
    v_exp_f32 v133, v21
    v_exp_f32 v134, v22
    v_exp_f32 v135, v23
    v_cvt_pk_bf16_f32 v80, v128, v129
    v_cvt_pk_bf16_f32 v81, v130, v131
    v_mfma_f32_32x32x16_bf16 v[48:63], v[124:127], v[84:87], v[48:63]
    v_exp_f32 v136, v24
    v_exp_f32 v137, v25
    v_cvt_pk_bf16_f32 v82, v132, v133
    v_cvt_pk_bf16_f32 v83, v134, v135
    v_exp_f32 v138, v26
    v_exp_f32 v139, v27
    s_waitcnt lgkmcnt(2)
    v_mfma_f32_32x32x16_bf16 v[48:63], v[112:115], v[80:83], v[48:63]
    s_mov_b64 exec, s[46:47]
    ds_read_b128 v[120:123], v10 offset:7680
    ds_read_b128 v[124:127], v10 offset:8320
    s_mov_b64 exec, -1
    v_exp_f32 v140, v28
    v_exp_f32 v141, v29
    v_exp_f32 v142, v30
    v_exp_f32 v143, v31
    v_cvt_pk_bf16_f32 v84, v136, v137
    v_cvt_pk_bf16_f32 v85, v138, v139
    s_waitcnt lgkmcnt(2)
    v_mfma_f32_32x32x16_bf16 v[16:31], v[96:99], v[88:91], v[64:79]
    v_exp_f32 v128, v32
    v_exp_f32 v129, v33
    v_exp_f32 v130, v34
    v_exp_f32 v131, v35
    v_cvt_pk_bf16_f32 v86, v140, v141
    v_cvt_pk_bf16_f32 v87, v142, v143
    v_mfma_f32_32x32x8_bf16 v[16:31], v[100:101], v[92:93], v[16:31]
    ds_read_b128 v[104:107], v8 offset:12800
    ds_read_b64 v[108:109], v9 offset:12800
    v_exp_f32 v132, v36
    v_exp_f32 v133, v37
    v_exp_f32 v134, v38
    v_exp_f32 v135, v39
    v_cvt_pk_bf16_f32 v80, v128, v129
    v_cvt_pk_bf16_f32 v81, v130, v131
    v_mfma_f32_32x32x16_bf16 v[48:63], v[116:119], v[84:87], v[48:63]
    v_exp_f32 v136, v40
    v_exp_f32 v137, v41
    v_cvt_pk_bf16_f32 v82, v132, v133
    v_cvt_pk_bf16_f32 v83, v134, v135
    v_exp_f32 v138, v42
    v_exp_f32 v139, v43
    s_waitcnt lgkmcnt(2)
    v_mfma_f32_32x32x16_bf16 v[48:63], v[120:123], v[80:83], v[48:63]
    s_mov_b64 exec, s[46:47]
    ds_read_b128 v[112:115], v10 offset:10240
    ds_read_b128 v[116:119], v10 offset:10880
    s_mov_b64 exec, -1
    v_exp_f32 v140, v44
    v_exp_f32 v141, v45
    v_exp_f32 v142, v46
    v_exp_f32 v143, v47
    v_cvt_pk_bf16_f32 v84, v136, v137
    v_cvt_pk_bf16_f32 v85, v138, v139
    s_waitcnt lgkmcnt(2)
    v_mfma_f32_32x32x16_bf16 v[32:47], v[104:107], v[88:91], v[64:79]
    v_exp_f32 v128, v16
    v_exp_f32 v129, v17
    v_exp_f32 v130, v18
    v_exp_f32 v131, v19
    v_cvt_pk_bf16_f32 v86, v140, v141
    v_cvt_pk_bf16_f32 v87, v142, v143
    v_mfma_f32_32x32x8_bf16 v[32:47], v[108:109], v[92:93], v[32:47]
    ds_read_b128 v[96:99], v8 offset:15360
    ds_read_b64 v[100:101], v9 offset:15360
    v_exp_f32 v132, v20
    v_exp_f32 v133, v21
    v_exp_f32 v134, v22
    v_exp_f32 v135, v23
    v_cvt_pk_bf16_f32 v80, v128, v129
    v_cvt_pk_bf16_f32 v81, v130, v131
    v_mfma_f32_32x32x16_bf16 v[48:63], v[124:127], v[84:87], v[48:63]
    v_exp_f32 v136, v24
    v_exp_f32 v137, v25
    v_cvt_pk_bf16_f32 v82, v132, v133
    v_cvt_pk_bf16_f32 v83, v134, v135
    v_exp_f32 v138, v26
    v_exp_f32 v139, v27
    s_waitcnt lgkmcnt(2)
    v_mfma_f32_32x32x16_bf16 v[48:63], v[112:115], v[80:83], v[48:63]
    s_mov_b64 exec, s[46:47]
    ds_read_b128 v[120:123], v10 offset:12800
    ds_read_b128 v[124:127], v10 offset:13440
    s_mov_b64 exec, -1
    v_exp_f32 v140, v28
    v_exp_f32 v141, v29
    v_exp_f32 v142, v30
    v_exp_f32 v143, v31
    v_cvt_pk_bf16_f32 v84, v136, v137
    v_cvt_pk_bf16_f32 v85, v138, v139
    s_waitcnt lgkmcnt(2)
    v_mfma_f32_32x32x16_bf16 v[16:31], v[96:99], v[88:91], v[64:79]
    v_exp_f32 v128, v32
    v_exp_f32 v129, v33
    v_exp_f32 v130, v34
    v_exp_f32 v131, v35
    v_cvt_pk_bf16_f32 v86, v140, v141
    v_cvt_pk_bf16_f32 v87, v142, v143
    v_mfma_f32_32x32x8_bf16 v[16:31], v[100:101], v[92:93], v[16:31]
    ds_read_b128 v[104:107], v8 offset:17920
    ds_read_b64 v[108:109], v9 offset:17920
    v_exp_f32 v132, v36
    v_exp_f32 v133, v37
    v_exp_f32 v134, v38
    v_exp_f32 v135, v39
    v_cvt_pk_bf16_f32 v80, v128, v129
    v_cvt_pk_bf16_f32 v81, v130, v131
    v_mfma_f32_32x32x16_bf16 v[48:63], v[116:119], v[84:87], v[48:63]
    v_exp_f32 v136, v40
    v_exp_f32 v137, v41
    v_cvt_pk_bf16_f32 v82, v132, v133
    v_cvt_pk_bf16_f32 v83, v134, v135
    v_exp_f32 v138, v42
    v_exp_f32 v139, v43
    s_waitcnt lgkmcnt(2)
    v_mfma_f32_32x32x16_bf16 v[48:63], v[120:123], v[80:83], v[48:63]
    s_mov_b64 exec, s[46:47]
    ds_read_b128 v[112:115], v10 offset:15360
    ds_read_b128 v[116:119], v10 offset:16000
    s_mov_b64 exec, -1
    v_exp_f32 v140, v44
    v_exp_f32 v141, v45
    v_exp_f32 v142, v46
    v_exp_f32 v143, v47
    v_cvt_pk_bf16_f32 v84, v136, v137
    v_cvt_pk_bf16_f32 v85, v138, v139
    s_waitcnt lgkmcnt(2)
    v_mfma_f32_32x32x16_bf16 v[32:47], v[104:107], v[88:91], v[64:79]
    v_exp_f32 v128, v16
    v_exp_f32 v129, v17
    v_exp_f32 v130, v18
    v_exp_f32 v131, v19
    v_cvt_pk_bf16_f32 v86, v140, v141
    v_cvt_pk_bf16_f32 v87, v142, v143
    v_mfma_f32_32x32x8_bf16 v[32:47], v[108:109], v[92:93], v[32:47]
    ds_read_b128 v[96:99], v8 offset:20480
    ds_read_b64 v[100:101], v9 offset:20480
    v_exp_f32 v132, v20
    v_exp_f32 v133, v21
    v_exp_f32 v134, v22
    v_exp_f32 v135, v23
    v_cvt_pk_bf16_f32 v80, v128, v129
    v_cvt_pk_bf16_f32 v81, v130, v131
    v_mfma_f32_32x32x16_bf16 v[48:63], v[124:127], v[84:87], v[48:63]
    v_exp_f32 v136, v24
    v_exp_f32 v137, v25
    v_cvt_pk_bf16_f32 v82, v132, v133
    v_cvt_pk_bf16_f32 v83, v134, v135
    v_exp_f32 v138, v26
    v_exp_f32 v139, v27
    s_waitcnt lgkmcnt(2)
    v_mfma_f32_32x32x16_bf16 v[48:63], v[112:115], v[80:83], v[48:63]
    s_mov_b64 exec, s[46:47]
    ds_read_b128 v[120:123], v10 offset:17920
    ds_read_b128 v[124:127], v10 offset:18560
    s_mov_b64 exec, -1
    v_exp_f32 v140, v28
    v_exp_f32 v141, v29
    v_exp_f32 v142, v30
    v_exp_f32 v143, v31
    v_cvt_pk_bf16_f32 v84, v136, v137
    v_cvt_pk_bf16_f32 v85, v138, v139
    s_waitcnt lgkmcnt(2)
    v_mfma_f32_32x32x16_bf16 v[16:31], v[96:99], v[88:91], v[64:79]
    v_exp_f32 v128, v32
    v_exp_f32 v129, v33
    v_exp_f32 v130, v34
    v_exp_f32 v131, v35
    v_cvt_pk_bf16_f32 v86, v140, v141
    v_cvt_pk_bf16_f32 v87, v142, v143
    v_mfma_f32_32x32x8_bf16 v[16:31], v[100:101], v[92:93], v[16:31]
    ds_read_b128 v[104:107], v8 offset:23040
    ds_read_b64 v[108:109], v9 offset:23040
    v_exp_f32 v132, v36
    v_exp_f32 v133, v37
    v_exp_f32 v134, v38
    v_exp_f32 v135, v39
    v_cvt_pk_bf16_f32 v80, v128, v129
    v_cvt_pk_bf16_f32 v81, v130, v131
    v_mfma_f32_32x32x16_bf16 v[48:63], v[116:119], v[84:87], v[48:63]
    v_exp_f32 v136, v40
    v_exp_f32 v137, v41
    v_cvt_pk_bf16_f32 v82, v132, v133
    v_cvt_pk_bf16_f32 v83, v134, v135
    v_exp_f32 v138, v42
    v_exp_f32 v139, v43
    s_waitcnt lgkmcnt(2)
    v_mfma_f32_32x32x16_bf16 v[48:63], v[120:123], v[80:83], v[48:63]
    s_mov_b64 exec, s[46:47]
    ds_read_b128 v[112:115], v10 offset:20480
    ds_read_b128 v[116:119], v10 offset:21120
    s_mov_b64 exec, -1
    v_exp_f32 v140, v44
    v_exp_f32 v141, v45
    v_exp_f32 v142, v46
    v_exp_f32 v143, v47
    v_cvt_pk_bf16_f32 v84, v136, v137
    v_cvt_pk_bf16_f32 v85, v138, v139
    v_add_u32 v8, 20480, v8
    v_add_u32 v9, 20480, v9
    v_add_u32 v10, 20480, v10
    s_add_u32 s51, s51, 1
    s_cmp_lt_u32 s51, 7
    s_cbranch_scc1 K2_loop
    s_waitcnt lgkmcnt(2)
    v_mfma_f32_32x32x16_bf16 v[32:47], v[104:107], v[88:91], v[64:79]
    v_exp_f32 v128, v16
    v_exp_f32 v129, v17
    v_exp_f32 v130, v18
    v_exp_f32 v131, v19
    v_cvt_pk_bf16_f32 v86, v140, v141
    v_cvt_pk_bf16_f32 v87, v142, v143
    v_mfma_f32_32x32x8_bf16 v[32:47], v[108:109], v[92:93], v[32:47]
    ds_read_b128 v[96:99], v8 offset:5120
    ds_read_b64 v[100:101], v9 offset:5120
    v_exp_f32 v132, v20
    v_exp_f32 v133, v21
    v_exp_f32 v134, v22
    v_exp_f32 v135, v23
    v_cvt_pk_bf16_f32 v80, v128, v129
    v_cvt_pk_bf16_f32 v81, v130, v131
    v_mfma_f32_32x32x16_bf16 v[48:63], v[124:127], v[84:87], v[48:63]
    v_exp_f32 v136, v24
    v_exp_f32 v137, v25
    v_cvt_pk_bf16_f32 v82, v132, v133
    v_cvt_pk_bf16_f32 v83, v134, v135
    v_exp_f32 v138, v26
    v_exp_f32 v139, v27
    s_waitcnt lgkmcnt(2)
    v_mfma_f32_32x32x16_bf16 v[48:63], v[112:115], v[80:83], v[48:63]
    s_mov_b64 exec, s[46:47]
    ds_read_b128 v[120:123], v10 offset:2560
    ds_read_b128 v[124:127], v10 offset:3200
    s_mov_b64 exec, -1
    v_exp_f32 v140, v28
    v_exp_f32 v141, v29
    v_exp_f32 v142, v30
    v_exp_f32 v143, v31
    v_cvt_pk_bf16_f32 v84, v136, v137
    v_cvt_pk_bf16_f32 v85, v138, v139
    s_waitcnt lgkmcnt(2)
    v_mfma_f32_32x32x16_bf16 v[16:31], v[96:99], v[88:91], v[64:79]
    v_exp_f32 v128, v32
    v_exp_f32 v129, v33
    v_exp_f32 v130, v34
    v_exp_f32 v131, v35
    v_cvt_pk_bf16_f32 v86, v140, v141
    v_cvt_pk_bf16_f32 v87, v142, v143
    v_mfma_f32_32x32x8_bf16 v[16:31], v[100:101], v[92:93], v[16:31]
    ds_read_b128 v[104:107], v8 offset:7680
    ds_read_b64 v[108:109], v9 offset:7680
    v_exp_f32 v132, v36
    v_exp_f32 v133, v37
    v_exp_f32 v134, v38
    v_exp_f32 v135, v39
    v_cvt_pk_bf16_f32 v80, v128, v129
    v_cvt_pk_bf16_f32 v81, v130, v131
    v_mfma_f32_32x32x16_bf16 v[48:63], v[116:119], v[84:87], v[48:63]
    v_exp_f32 v136, v40
    v_exp_f32 v137, v41
    v_cvt_pk_bf16_f32 v82, v132, v133
    v_cvt_pk_bf16_f32 v83, v134, v135
    v_exp_f32 v138, v42
    v_exp_f32 v139, v43
    s_waitcnt lgkmcnt(2)
    v_mfma_f32_32x32x16_bf16 v[48:63], v[120:123], v[80:83], v[48:63]
    s_mov_b64 exec, s[46:47]
    ds_read_b128 v[112:115], v10 offset:5120
    ds_read_b128 v[116:119], v10 offset:5760
    s_mov_b64 exec, -1
    v_exp_f32 v140, v44
    v_exp_f32 v141, v45
    v_exp_f32 v142, v46
    v_exp_f32 v143, v47
    v_cvt_pk_bf16_f32 v84, v136, v137
    v_cvt_pk_bf16_f32 v85, v138, v139
    s_waitcnt lgkmcnt(2)
    v_mfma_f32_32x32x16_bf16 v[32:47], v[104:107], v[88:91], v[64:79]
    v_exp_f32 v128, v16
    v_exp_f32 v129, v17
    v_exp_f32 v130, v18
    v_exp_f32 v131, v19
    v_cvt_pk_bf16_f32 v86, v140, v141
    v_cvt_pk_bf16_f32 v87, v142, v143
    v_mfma_f32_32x32x8_bf16 v[32:47], v[108:109], v[92:93], v[32:47]
    ds_read_b128 v[96:99], v8 offset:10240
    ds_read_b64 v[100:101], v9 offset:10240
    v_exp_f32 v132, v20
    v_exp_f32 v133, v21
    v_exp_f32 v134, v22
    v_exp_f32 v135, v23
    v_cvt_pk_bf16_f32 v80, v128, v129
    v_cvt_pk_bf16_f32 v81, v130, v131
    v_mfma_f32_32x32x16_bf16 v[48:63], v[124:127], v[84:87], v[48:63]
    v_exp_f32 v136, v24
    v_exp_f32 v137, v25
    v_cvt_pk_bf16_f32 v82, v132, v133
    v_cvt_pk_bf16_f32 v83, v134, v135
    v_exp_f32 v138, v26
    v_exp_f32 v139, v27
    s_waitcnt lgkmcnt(2)
    v_mfma_f32_32x32x16_bf16 v[48:63], v[112:115], v[80:83], v[48:63]
    s_mov_b64 exec, s[46:47]
    ds_read_b128 v[120:123], v10 offset:7680
    ds_read_b128 v[124:127], v10 offset:8320
    s_mov_b64 exec, -1
    v_exp_f32 v140, v28
    v_exp_f32 v141, v29
    v_exp_f32 v142, v30
    v_exp_f32 v143, v31
    v_cvt_pk_bf16_f32 v84, v136, v137
    v_cvt_pk_bf16_f32 v85, v138, v139
    s_waitcnt lgkmcnt(2)
    v_mfma_f32_32x32x16_bf16 v[16:31], v[96:99], v[88:91], v[64:79]
    v_exp_f32 v128, v32
    v_exp_f32 v129, v33
    v_exp_f32 v130, v34
    v_exp_f32 v131, v35
    v_cvt_pk_bf16_f32 v86, v140, v141
    v_cvt_pk_bf16_f32 v87, v142, v143
    v_mfma_f32_32x32x8_bf16 v[16:31], v[100:101], v[92:93], v[16:31]
    ds_read_b128 v[104:107], v8 offset:12800
    ds_read_b64 v[108:109], v9 offset:12800
    v_exp_f32 v132, v36
    v_exp_f32 v133, v37
    v_exp_f32 v134, v38
    v_exp_f32 v135, v39
    v_cvt_pk_bf16_f32 v80, v128, v129
    v_cvt_pk_bf16_f32 v81, v130, v131
    v_mfma_f32_32x32x16_bf16 v[48:63], v[116:119], v[84:87], v[48:63]
    v_exp_f32 v136, v40
    v_exp_f32 v137, v41
    v_cvt_pk_bf16_f32 v82, v132, v133
    v_cvt_pk_bf16_f32 v83, v134, v135
    v_exp_f32 v138, v42
    v_exp_f32 v139, v43
    s_waitcnt lgkmcnt(2)
    v_mfma_f32_32x32x16_bf16 v[48:63], v[120:123], v[80:83], v[48:63]
    s_mov_b64 exec, s[46:47]
    ds_read_b128 v[112:115], v10 offset:10240
    ds_read_b128 v[116:119], v10 offset:10880
    s_mov_b64 exec, -1
    v_exp_f32 v140, v44
    v_exp_f32 v141, v45
    v_exp_f32 v142, v46
    v_exp_f32 v143, v47
    v_cvt_pk_bf16_f32 v84, v136, v137
    v_cvt_pk_bf16_f32 v85, v138, v139
    s_waitcnt lgkmcnt(2)
    v_mfma_f32_32x32x16_bf16 v[32:47], v[104:107], v[88:91], v[64:79]
    v_exp_f32 v128, v16
    v_exp_f32 v129, v17
    v_exp_f32 v130, v18
    v_exp_f32 v131, v19
    v_cvt_pk_bf16_f32 v86, v140, v141
    v_cvt_pk_bf16_f32 v87, v142, v143
    v_mfma_f32_32x32x8_bf16 v[32:47], v[108:109], v[92:93], v[32:47]
    ds_read_b128 v[96:99], v8 offset:15360
    ds_read_b64 v[100:101], v9 offset:15360
    v_exp_f32 v132, v20
    v_exp_f32 v133, v21
    v_exp_f32 v134, v22
    v_exp_f32 v135, v23
    v_cvt_pk_bf16_f32 v80, v128, v129
    v_cvt_pk_bf16_f32 v81, v130, v131
    v_mfma_f32_32x32x16_bf16 v[48:63], v[124:127], v[84:87], v[48:63]
    v_exp_f32 v136, v24
    v_exp_f32 v137, v25
    v_cvt_pk_bf16_f32 v82, v132, v133
    v_cvt_pk_bf16_f32 v83, v134, v135
    v_exp_f32 v138, v26
    v_exp_f32 v139, v27
    s_waitcnt lgkmcnt(2)
    v_mfma_f32_32x32x16_bf16 v[48:63], v[112:115], v[80:83], v[48:63]
    s_mov_b64 exec, s[46:47]
    ds_read_b128 v[120:123], v10 offset:12800
    ds_read_b128 v[124:127], v10 offset:13440
    s_mov_b64 exec, -1
    v_exp_f32 v140, v28
    v_exp_f32 v141, v29
    v_exp_f32 v142, v30
    v_exp_f32 v143, v31
    v_cvt_pk_bf16_f32 v84, v136, v137
    v_cvt_pk_bf16_f32 v85, v138, v139
    s_waitcnt lgkmcnt(2)
    v_mfma_f32_32x32x16_bf16 v[16:31], v[96:99], v[88:91], v[64:79]
    v_exp_f32 v128, v32
    v_exp_f32 v129, v33
    v_exp_f32 v130, v34
    v_exp_f32 v131, v35
    v_cvt_pk_bf16_f32 v86, v140, v141
    v_cvt_pk_bf16_f32 v87, v142, v143
    v_mfma_f32_32x32x8_bf16 v[16:31], v[100:101], v[92:93], v[16:31]
    ds_read_b128 v[104:107], v8 offset:17920
    ds_read_b64 v[108:109], v9 offset:17920
    v_exp_f32 v132, v36
    v_exp_f32 v133, v37
    v_exp_f32 v134, v38
    v_exp_f32 v135, v39
    v_cvt_pk_bf16_f32 v80, v128, v129
    v_cvt_pk_bf16_f32 v81, v130, v131
    v_mfma_f32_32x32x16_bf16 v[48:63], v[116:119], v[84:87], v[48:63]
    v_exp_f32 v136, v40
    v_exp_f32 v137, v41
    v_cvt_pk_bf16_f32 v82, v132, v133
    v_cvt_pk_bf16_f32 v83, v134, v135
    v_exp_f32 v138, v42
    v_exp_f32 v139, v43
    s_waitcnt lgkmcnt(2)
    v_mfma_f32_32x32x16_bf16 v[48:63], v[120:123], v[80:83], v[48:63]
    s_mov_b64 exec, s[46:47]
    ds_read_b128 v[112:115], v10 offset:15360
    ds_read_b128 v[116:119], v10 offset:16000
    s_mov_b64 exec, -1
    v_exp_f32 v140, v44
    v_exp_f32 v141, v45
    v_exp_f32 v142, v46
    v_exp_f32 v143, v47
    v_cvt_pk_bf16_f32 v84, v136, v137
    v_cvt_pk_bf16_f32 v85, v138, v139
    s_waitcnt lgkmcnt(2)
    v_mfma_f32_32x32x16_bf16 v[32:47], v[104:107], v[88:91], v[64:79]
    v_exp_f32 v128, v16
    v_exp_f32 v129, v17
    v_exp_f32 v130, v18
    v_exp_f32 v131, v19
    v_cvt_pk_bf16_f32 v86, v140, v141
    v_cvt_pk_bf16_f32 v87, v142, v143
    v_mfma_f32_32x32x8_bf16 v[32:47], v[108:109], v[92:93], v[32:47]
    s_waitcnt lgkmcnt(0)
    v_exp_f32 v132, v20
    v_exp_f32 v133, v21
    v_exp_f32 v134, v22
    v_exp_f32 v135, v23
    v_cvt_pk_bf16_f32 v80, v128, v129
    v_cvt_pk_bf16_f32 v81, v130, v131
    v_mfma_f32_32x32x16_bf16 v[48:63], v[124:127], v[84:87], v[48:63]
    v_exp_f32 v136, v24
    v_exp_f32 v137, v25
    v_cvt_pk_bf16_f32 v82, v132, v133
    v_cvt_pk_bf16_f32 v83, v134, v135
    v_exp_f32 v138, v26
    v_exp_f32 v139, v27
    s_waitcnt lgkmcnt(2)
    v_mfma_f32_32x32x16_bf16 v[48:63], v[112:115], v[80:83], v[48:63]
    s_mov_b64 exec, s[46:47]
    ds_read_b128 v[120:123], v10 offset:17920
    ds_read_b128 v[124:127], v10 offset:18560
    s_mov_b64 exec, -1
    v_exp_f32 v140, v28
    v_exp_f32 v141, v29
    v_exp_f32 v142, v30
    v_exp_f32 v143, v31
    v_cvt_pk_bf16_f32 v84, v136, v137
    v_cvt_pk_bf16_f32 v85, v138, v139
    s_waitcnt lgkmcnt(2)
    v_exp_f32 v128, v32
    v_exp_f32 v129, v33
    v_exp_f32 v130, v34
    v_exp_f32 v131, v35
    v_cvt_pk_bf16_f32 v86, v140, v141
    v_cvt_pk_bf16_f32 v87, v142, v143
    s_waitcnt lgkmcnt(0)
    v_exp_f32 v132, v36
    v_exp_f32 v133, v37
    v_exp_f32 v134, v38
    v_exp_f32 v135, v39
    v_cvt_pk_bf16_f32 v80, v128, v129
    v_cvt_pk_bf16_f32 v81, v130, v131
    v_mfma_f32_32x32x16_bf16 v[48:63], v[116:119], v[84:87], v[48:63]
    v_exp_f32 v136, v40
    v_exp_f32 v137, v41
    v_cvt_pk_bf16_f32 v82, v132, v133
    v_cvt_pk_bf16_f32 v83, v134, v135
    v_exp_f32 v138, v42
    v_exp_f32 v139, v43
    s_waitcnt lgkmcnt(2)
    v_mfma_f32_32x32x16_bf16 v[48:63], v[120:123], v[80:83], v[48:63]
    v_exp_f32 v140, v44
    v_exp_f32 v141, v45
    v_exp_f32 v142, v46
    v_exp_f32 v143, v47
    v_cvt_pk_bf16_f32 v84, v136, v137
    v_cvt_pk_bf16_f32 v85, v138, v139
    v_cvt_pk_bf16_f32 v86, v140, v141
    v_cvt_pk_bf16_f32 v87, v142, v143
    s_nop 1
    v_mfma_f32_32x32x16_bf16 v[48:63], v[124:127], v[84:87], v[48:63]
    s_nop 7
    s_nop 7
    v_mov_b32 v5, v56
    v_mov_b32 v6, v56
    s_nop 1
    v_permlane32_swap_b32 v5, v6
    s_cmp_lg_u32 s50, 0
    s_cbranch_scc1 K2_fin
    s_mov_b32 s52, 0x71800000
    v_cmp_nlt_f32 vcc, v6, s52
    s_cbranch_vccz K2_fin
    s_mov_b32 s50, 1
    v_mov_b32 v5, 0xff800000
    s_mov_b32 s51, 0
    v_lshlrev_b32 v8, 4, v1
    v_lshl_add_u32 v8, v2, 9, v8
    v_lshlrev_b32 v9, 3, v1
    v_add_u32 v9, 1024, v9
K2_fb:
    ds_read_b128 v[96:99], v8 offset:0
    ds_read_b64 v[100:101], v9 offset:0
    s_waitcnt lgkmcnt(0)
    v_mfma_f32_32x32x16_bf16 v[16:31], v[96:99], v[88:91], 0
    v_mfma_f32_32x32x8_bf16 v[16:31], v[100:101], v[92:93], v[16:31]
    s_nop 7
    s_nop 7
    v_max3_f32 v5, v5, v16, v17
    v_max3_f32 v5, v5, v18, v19
    v_max3_f32 v5, v5, v20, v21
    v_max3_f32 v5, v5, v22, v23
    v_max3_f32 v5, v5, v24, v25
    v_max3_f32 v5, v5, v26, v27
    v_max3_f32 v5, v5, v28, v29
    v_max3_f32 v5, v5, v30, v31
    v_add_u32 v8, 2560, v8
    v_add_u32 v9, 2560, v9
    s_add_u32 s51, s51, 1
    s_cmp_lt_u32 s51, 64
    s_cbranch_scc1 K2_fb
    v_mov_b32 v6, v5
    s_nop 1
    v_permlane32_swap_b32 v5, v6
    v_max_f32 v5, v5, v6
    s_branch K2_main
K2_fin:
    v_rcp_f32 v6, v6
    v_sub_f32 v5, 1.0, v11
    s_nop 0
    v_mul_f32 v6, v6, v5
    v_mul_f32 v48, v48, v6
    v_mul_f32 v49, v49, v6
    v_mul_f32 v50, v50, v6
    v_mul_f32 v51, v51, v6
    v_mul_f32 v52, v52, v6
    v_mul_f32 v53, v53, v6
    v_mul_f32 v54, v54, v6
    v_mul_f32 v55, v55, v6
    v_mul_f32 v56, v56, v6
    v_mul_f32 v57, v57, v6
    v_mul_f32 v58, v58, v6
    v_mul_f32 v59, v59, v6
    v_cvt_pk_bf16_f32 v48, v48, v49
    v_cvt_pk_bf16_f32 v49, v50, v51
    v_cvt_pk_bf16_f32 v52, v52, v53
    v_cvt_pk_bf16_f32 v53, v54, v55
    v_cvt_pk_bf16_f32 v56, v56, v57
    v_cvt_pk_bf16_f32 v57, v58, v59
    s_add_u32 s62, s62, 81920
    buffer_store_dwordx2 v[48:49], v14, s[32:35], s62 offen
    buffer_store_dwordx2 v[52:53], v14, s[32:35], s62 offen offset:1024
    buffer_store_dwordx2 v[56:57], v15, s[32:35], s62 offen
    s_endpgm
K2_help:
    s_sub_u32 s49, s48, 8
    v_lshlrev_b32 v9, 4, v0
    s_mul_i32 s60, s40, 163840
    s_add_u32 s60, s60, 2621440
    s_lshl_b32 s61, s49, 10
    s_add_u32 s60, s60, s61
    s_mov_b32 m0, s61
    buffer_load_dwordx4 v9, s[32:35], s60 offen lds
    s_add_u32 s61, s61, 4096
    s_mov_b32 m0, s61
    s_add_u32 s60, s60, 4096
    buffer_load_dwordx4 v9, s[32:35], s60 offen lds
    s_add_u32 s61, s61, 4096
    s_mov_b32 m0, s61
    s_add_u32 s60, s60, 4096
    buffer_load_dwordx4 v9, s[32:35], s60 offen lds
    s_add_u32 s61, s61, 4096
    s_mov_b32 m0, s61
    s_add_u32 s60, s60, 4096
    buffer_load_dwordx4 v9, s[32:35], s60 offen lds
    s_add_u32 s61, s61, 4096
    s_mov_b32 m0, s61
    s_add_u32 s60, s60, 4096
    buffer_load_dwordx4 v9, s[32:35], s60 offen lds
    s_add_u32 s61, s61, 4096
    s_mov_b32 m0, s61
    s_add_u32 s60, s60, 4096
    buffer_load_dwordx4 v9, s[32:35], s60 offen lds
    s_add_u32 s61, s61, 4096
    s_mov_b32 m0, s61
    s_add_u32 s60, s60, 4096
    buffer_load_dwordx4 v9, s[32:35], s60 offen lds
    s_add_u32 s61, s61, 4096
    s_mov_b32 m0, s61
    s_add_u32 s60, s60, 4096
    buffer_load_dwordx4 v9, s[32:35], s60 offen lds
    s_add_u32 s61, s61, 4096
    s_mov_b32 m0, s61
    s_add_u32 s60, s60, 4096
    v_lshlrev_b32 v8, 4, v1
    v_mul_u32_u24 v5, 320, v2
    v_add_u32 v8, v8, v5
    s_mul_i32 s54, s40, 163840
    s_mul_i32 s45, s49, 40960
    s_add_u32 s54, s54, s45
    s_add_u32 s54, s54, 10485760
    v_cmp_eq_u32 vcc, 20, v1
    v_mov_b32 v5, 0
    v_mov_b32 v7, 0x3f803f80
    s_mov_b32 s46, 0x000fffff
    v_cndmask_b32 v5, v5, v7, vcc
    s_mov_b32 s47, 0x000fffff
    v_mov_b32 v32, 0
    v_mov_b32 v36, v5
    v_mov_b32 v33, 0
    v_mov_b32 v37, v5
    v_mov_b32 v34, 0
    v_mov_b32 v38, v5
    v_mov_b32 v35, 0
    v_mov_b32 v39, v5
    v_mov_b32 v40, 0
    v_mov_b32 v44, v5
    v_mov_b32 v41, 0
    v_mov_b32 v45, v5
    v_mov_b32 v42, 0
    v_mov_b32 v46, v5
    v_mov_b32 v43, 0
    v_mov_b32 v47, v5
    v_mov_b32 v48, 0
    v_mov_b32 v52, v5
    v_mov_b32 v49, 0
    v_mov_b32 v53, v5
    v_mov_b32 v50, 0
    v_mov_b32 v54, v5
    v_mov_b32 v51, 0
    v_mov_b32 v55, v5
    v_mov_b32 v56, 0
    v_mov_b32 v60, v5
    v_mov_b32 v57, 0
    v_mov_b32 v61, v5
    v_mov_b32 v58, 0
    v_mov_b32 v62, v5
    v_mov_b32 v59, 0
    v_mov_b32 v63, v5
    v_mov_b32 v16, 0
    v_mov_b32 v17, 0
    v_mov_b32 v18, 0
    v_mov_b32 v19, 0
    v_mov_b32 v20, 0
    v_mov_b32 v21, 0
    v_mov_b32 v22, 0
    v_mov_b32 v23, 0
    v_mov_b32 v24, 0
    v_mov_b32 v25, 0
    v_mov_b32 v26, 0
    v_mov_b32 v27, 0
    v_mov_b32 v28, 0
    v_mov_b32 v29, 0
    v_mov_b32 v30, 0
    v_mov_b32 v31, 0
    s_waitcnt vmcnt(0)
    s_barrier
    buffer_load_dwordx4 v9, s[32:35], s60 offen lds
    s_add_u32 s61, s61, 4096
    s_mov_b32 m0, s61
    s_add_u32 s60, s60, 4096
    buffer_load_dwordx4 v9, s[32:35], s60 offen lds
    s_add_u32 s61, s61, 4096
    s_mov_b32 m0, s61
    s_add_u32 s60, s60, 4096
    buffer_load_dwordx4 v9, s[32:35], s60 offen lds
    s_add_u32 s61, s61, 4096
    s_mov_b32 m0, s61
    s_add_u32 s60, s60, 4096
    buffer_load_dwordx4 v9, s[32:35], s60 offen lds
    s_add_u32 s61, s61, 4096
    s_mov_b32 m0, s61
    s_add_u32 s60, s60, 4096
    buffer_load_dwordx4 v9, s[32:35], s60 offen lds
    s_add_u32 s61, s61, 4096
    s_mov_b32 m0, s61
    s_add_u32 s60, s60, 4096
    buffer_load_dwordx4 v9, s[32:35], s60 offen lds
    s_add_u32 s61, s61, 4096
    s_mov_b32 m0, s61
    s_add_u32 s60, s60, 4096
    buffer_load_dwordx4 v9, s[32:35], s60 offen lds
    s_add_u32 s61, s61, 4096
    s_mov_b32 m0, s61
    s_add_u32 s60, s60, 4096
    buffer_load_dwordx4 v9, s[32:35], s60 offen lds
    s_add_u32 s61, s61, 4096
    s_mov_b32 m0, s61
    s_add_u32 s60, s60, 4096
    buffer_load_dwordx4 v9, s[32:35], s60 offen lds
    s_add_u32 s61, s61, 4096
    s_mov_b32 m0, s61
    s_add_u32 s60, s60, 4096
    buffer_load_dwordx4 v9, s[32:35], s60 offen lds
    s_add_u32 s61, s61, 4096
    s_mov_b32 m0, s61
    s_add_u32 s60, s60, 4096
    buffer_load_dwordx4 v9, s[32:35], s60 offen lds
    s_add_u32 s61, s61, 4096
    s_mov_b32 m0, s61
    s_add_u32 s60, s60, 4096
    buffer_load_dwordx4 v9, s[32:35], s60 offen lds
    s_add_u32 s61, s61, 4096
    s_mov_b32 m0, s61
    s_add_u32 s60, s60, 4096
    buffer_load_dwordx4 v9, s[32:35], s60 offen lds
    s_add_u32 s61, s61, 4096
    s_mov_b32 m0, s61
    s_add_u32 s60, s60, 4096
    buffer_load_dwordx4 v9, s[32:35], s60 offen lds
    s_add_u32 s61, s61, 4096
    s_mov_b32 m0, s61
    s_add_u32 s60, s60, 4096
    buffer_load_dwordx4 v9, s[32:35], s60 offen lds
    s_add_u32 s61, s61, 4096
    s_mov_b32 m0, s61
    s_add_u32 s60, s60, 4096
    buffer_load_dwordx4 v9, s[32:35], s60 offen lds
    s_add_u32 s61, s61, 4096
    s_mov_b32 m0, s61
    s_add_u32 s60, s60, 4096
    buffer_load_dwordx4 v9, s[32:35], s60 offen lds
    s_add_u32 s61, s61, 4096
    s_mov_b32 m0, s61
    s_add_u32 s60, s60, 4096
    buffer_load_dwordx4 v9, s[32:35], s60 offen lds
    s_add_u32 s61, s61, 4096
    s_mov_b32 m0, s61
    s_add_u32 s60, s60, 4096
    buffer_load_dwordx4 v9, s[32:35], s60 offen lds
    s_add_u32 s61, s61, 4096
    s_mov_b32 m0, s61
    s_add_u32 s60, s60, 4096
    buffer_load_dwordx4 v9, s[32:35], s60 offen lds
    s_add_u32 s61, s61, 4096
    s_mov_b32 m0, s61
    s_add_u32 s60, s60, 4096
    buffer_load_dwordx4 v9, s[32:35], s60 offen lds
    s_add_u32 s61, s61, 4096
    s_mov_b32 m0, s61
    s_add_u32 s60, s60, 4096
    buffer_load_dwordx4 v9, s[32:35], s60 offen lds
    s_add_u32 s61, s61, 4096
    s_mov_b32 m0, s61
    s_add_u32 s60, s60, 4096
    buffer_load_dwordx4 v9, s[32:35], s60 offen lds
    s_add_u32 s61, s61, 4096
    s_mov_b32 m0, s61
    s_add_u32 s60, s60, 4096
    buffer_load_dwordx4 v9, s[32:35], s60 offen lds
    s_add_u32 s61, s61, 4096
    s_mov_b32 m0, s61
    s_add_u32 s60, s60, 4096
    buffer_load_dwordx4 v9, s[32:35], s60 offen lds
    s_add_u32 s61, s61, 4096
    s_mov_b32 m0, s61
    s_add_u32 s60, s60, 4096
    buffer_load_dwordx4 v9, s[32:35], s60 offen lds
    s_add_u32 s61, s61, 4096
    s_mov_b32 m0, s61
    s_add_u32 s60, s60, 4096
    buffer_load_dwordx4 v9, s[32:35], s60 offen lds
    s_add_u32 s61, s61, 4096
    s_mov_b32 m0, s61
    s_add_u32 s60, s60, 4096
    buffer_load_dwordx4 v9, s[32:35], s60 offen lds
    s_add_u32 s61, s61, 4096
    s_mov_b32 m0, s61
    s_add_u32 s60, s60, 4096
    buffer_load_dwordx4 v9, s[32:35], s60 offen lds
    s_add_u32 s61, s61, 4096
    s_mov_b32 m0, s61
    s_add_u32 s60, s60, 4096
    buffer_load_dwordx4 v9, s[32:35], s60 offen lds
    s_add_u32 s61, s61, 4096
    s_mov_b32 m0, s61
    s_add_u32 s60, s60, 4096
    buffer_load_dwordx4 v9, s[32:35], s60 offen lds
    s_add_u32 s61, s61, 4096
    s_mov_b32 m0, s61
    s_add_u32 s60, s60, 4096
    buffer_load_dwordx4 v9, s[32:35], s60 offen lds
    s_add_u32 s61, s61, 4096
    s_mov_b32 m0, s61
    s_add_u32 s60, s60, 4096
    s_lshl_b32 s42, s41, 8
    s_lshl_b32 s43, s49, 6
    s_add_u32 s42, s42, s43
    v_add_u32 v3, s42, v1
    s_mul_i32 s44, s40, 81920
    s_mul_i32 s43, s42, 40
    s_add_u32 s44, s44, s43
    s_add_u32 s44, s44, 7864320
    v_lshlrev_b32 v4, 3, v1
    v_lshl_add_u32 v5, v2, 8, v4
    v_cmp_eq_u32 vcc, 0, v2
    v_add_u32 v6, 1024, v4
    v_mov_b32 v7, 0x80000000
    v_cndmask_b32 v6, v7, v6, vcc
    v_lshl_add_u32 v14, v2, 9, v4
    v_add_u32 v15, 2048, v4
    v_cndmask_b32 v15, v7, v15, vcc
    v_lshlrev_b32 v7, 2, v3
    s_mov_b32 s45, 22020096
    s_lshr_b32 s62, s42, 6
    s_mul_i32 s62, s62, 163840
    s_mul_i32 s43, s40, 2560
    s_add_u32 s62, s62, s43
    s_add_u32 s62, s62, 23666688
    s_waitcnt vmcnt(0)
    s_barrier
    buffer_load_dwordx2 v[112:113], v5, s[32:35], s44 offen offset:0
    buffer_load_dwordx2 v[114:115], v5, s[32:35], s44 offen offset:512
    buffer_load_dwordx2 v[116:117], v6, s[32:35], s44 offen offset:0
    buffer_load_dword v118, v7, s[32:35], s45 offen offset:0
    buffer_load_dwordx2 v[120:121], v5, s[32:35], s44 offen offset:1280
    buffer_load_dwordx2 v[122:123], v5, s[32:35], s44 offen offset:1792
    buffer_load_dwordx2 v[124:125], v6, s[32:35], s44 offen offset:1280
    buffer_load_dword v126, v7, s[32:35], s45 offen offset:128
    s_mov_b64 exec, s[46:47]
    s_add_u32 s55, s54, 0
    buffer_load_dwordx4 v[32:35], v8, s[32:35], s55 offen
    buffer_load_dwordx4 v[36:39], v8, s[32:35], s55 offen offset:1280
    s_add_u32 s55, s54, 640
    buffer_load_dwordx4 v[40:43], v8, s[32:35], s55 offen
    buffer_load_dwordx4 v[44:47], v8, s[32:35], s55 offen offset:1280
    s_add_u32 s55, s54, 2560
    buffer_load_dwordx4 v[48:51], v8, s[32:35], s55 offen
    buffer_load_dwordx4 v[52:55], v8, s[32:35], s55 offen offset:1280
    s_add_u32 s55, s54, 3200
    buffer_load_dwordx4 v[56:59], v8, s[32:35], s55 offen
    buffer_load_dwordx4 v[60:63], v8, s[32:35], s55 offen offset:1280
    s_waitcnt vmcnt(6)
    v_mfma_f32_32x32x16_bf16 v[16:31], v[32:35], v[36:39], v[16:31]
    s_add_u32 s55, s54, 5120
    buffer_load_dwordx4 v[32:35], v8, s[32:35], s55 offen
    buffer_load_dwordx4 v[36:39], v8, s[32:35], s55 offen offset:1280
    s_waitcnt vmcnt(6)
    v_mfma_f32_32x32x16_bf16 v[16:31], v[40:43], v[44:47], v[16:31]
    s_add_u32 s55, s54, 5760
    buffer_load_dwordx4 v[40:43], v8, s[32:35], s55 offen
    buffer_load_dwordx4 v[44:47], v8, s[32:35], s55 offen offset:1280
    s_waitcnt vmcnt(6)
    v_mfma_f32_32x32x16_bf16 v[16:31], v[48:51], v[52:55], v[16:31]
    s_add_u32 s55, s54, 7680
    buffer_load_dwordx4 v[48:51], v8, s[32:35], s55 offen
    buffer_load_dwordx4 v[52:55], v8, s[32:35], s55 offen offset:1280
    s_waitcnt vmcnt(6)
    v_mfma_f32_32x32x16_bf16 v[16:31], v[56:59], v[60:63], v[16:31]
    s_add_u32 s55, s54, 8320
    buffer_load_dwordx4 v[56:59], v8, s[32:35], s55 offen
    buffer_load_dwordx4 v[60:63], v8, s[32:35], s55 offen offset:1280
    s_waitcnt vmcnt(6)
    v_mfma_f32_32x32x16_bf16 v[16:31], v[32:35], v[36:39], v[16:31]
    s_add_u32 s55, s54, 10240
    buffer_load_dwordx4 v[32:35], v8, s[32:35], s55 offen
    buffer_load_dwordx4 v[36:39], v8, s[32:35], s55 offen offset:1280
    s_waitcnt vmcnt(6)
    v_mfma_f32_32x32x16_bf16 v[16:31], v[40:43], v[44:47], v[16:31]
    s_add_u32 s55, s54, 10880
    buffer_load_dwordx4 v[40:43], v8, s[32:35], s55 offen
    buffer_load_dwordx4 v[44:47], v8, s[32:35], s55 offen offset:1280
    s_waitcnt vmcnt(6)
    v_mfma_f32_32x32x16_bf16 v[16:31], v[48:51], v[52:55], v[16:31]
    s_add_u32 s55, s54, 12800
    buffer_load_dwordx4 v[48:51], v8, s[32:35], s55 offen
    buffer_load_dwordx4 v[52:55], v8, s[32:35], s55 offen offset:1280
    s_waitcnt vmcnt(6)
    v_mfma_f32_32x32x16_bf16 v[16:31], v[56:59], v[60:63], v[16:31]
    s_add_u32 s55, s54, 13440
    buffer_load_dwordx4 v[56:59], v8, s[32:35], s55 offen
    buffer_load_dwordx4 v[60:63], v8, s[32:35], s55 offen offset:1280
    s_waitcnt vmcnt(6)
    v_mfma_f32_32x32x16_bf16 v[16:31], v[32:35], v[36:39], v[16:31]
    s_add_u32 s55, s54, 15360
    buffer_load_dwordx4 v[32:35], v8, s[32:35], s55 offen
    buffer_load_dwordx4 v[36:39], v8, s[32:35], s55 offen offset:1280
    s_waitcnt vmcnt(6)
    v_mfma_f32_32x32x16_bf16 v[16:31], v[40:43], v[44:47], v[16:31]
    s_add_u32 s55, s54, 16000
    buffer_load_dwordx4 v[40:43], v8, s[32:35], s55 offen
    buffer_load_dwordx4 v[44:47], v8, s[32:35], s55 offen offset:1280
    s_waitcnt vmcnt(6)
    v_mfma_f32_32x32x16_bf16 v[16:31], v[48:51], v[52:55], v[16:31]
    s_add_u32 s55, s54, 17920
    buffer_load_dwordx4 v[48:51], v8, s[32:35], s55 offen
    buffer_load_dwordx4 v[52:55], v8, s[32:35], s55 offen offset:1280
    s_waitcnt vmcnt(6)
    v_mfma_f32_32x32x16_bf16 v[16:31], v[56:59], v[60:63], v[16:31]
    s_add_u32 s55, s54, 18560
    buffer_load_dwordx4 v[56:59], v8, s[32:35], s55 offen
    buffer_load_dwordx4 v[60:63], v8, s[32:35], s55 offen offset:1280
    s_waitcnt vmcnt(6)
    v_mfma_f32_32x32x16_bf16 v[16:31], v[32:35], v[36:39], v[16:31]
    s_add_u32 s55, s54, 20480
    buffer_load_dwordx4 v[32:35], v8, s[32:35], s55 offen
    buffer_load_dwordx4 v[36:39], v8, s[32:35], s55 offen offset:1280
    s_waitcnt vmcnt(6)
    v_mfma_f32_32x32x16_bf16 v[16:31], v[40:43], v[44:47], v[16:31]
    s_add_u32 s55, s54, 21120
    buffer_load_dwordx4 v[40:43], v8, s[32:35], s55 offen
    buffer_load_dwordx4 v[44:47], v8, s[32:35], s55 offen offset:1280
    s_waitcnt vmcnt(6)
    v_mfma_f32_32x32x16_bf16 v[16:31], v[48:51], v[52:55], v[16:31]
    s_add_u32 s55, s54, 23040
    buffer_load_dwordx4 v[48:51], v8, s[32:35], s55 offen
    buffer_load_dwordx4 v[52:55], v8, s[32:35], s55 offen offset:1280
    s_waitcnt vmcnt(6)
    v_mfma_f32_32x32x16_bf16 v[16:31], v[56:59], v[60:63], v[16:31]
    s_add_u32 s55, s54, 23680
    buffer_load_dwordx4 v[56:59], v8, s[32:35], s55 offen
    buffer_load_dwordx4 v[60:63], v8, s[32:35], s55 offen offset:1280
    s_waitcnt vmcnt(6)
    v_mfma_f32_32x32x16_bf16 v[16:31], v[32:35], v[36:39], v[16:31]
    s_add_u32 s55, s54, 25600
    buffer_load_dwordx4 v[32:35], v8, s[32:35], s55 offen
    buffer_load_dwordx4 v[36:39], v8, s[32:35], s55 offen offset:1280
    s_waitcnt vmcnt(6)
    v_mfma_f32_32x32x16_bf16 v[16:31], v[40:43], v[44:47], v[16:31]
    s_add_u32 s55, s54, 26240
    buffer_load_dwordx4 v[40:43], v8, s[32:35], s55 offen
    buffer_load_dwordx4 v[44:47], v8, s[32:35], s55 offen offset:1280
    s_waitcnt vmcnt(6)
    v_mfma_f32_32x32x16_bf16 v[16:31], v[48:51], v[52:55], v[16:31]
    s_add_u32 s55, s54, 28160
    buffer_load_dwordx4 v[48:51], v8, s[32:35], s55 offen
    buffer_load_dwordx4 v[52:55], v8, s[32:35], s55 offen offset:1280
    s_waitcnt vmcnt(6)
    v_mfma_f32_32x32x16_bf16 v[16:31], v[56:59], v[60:63], v[16:31]
    s_add_u32 s55, s54, 28800
    buffer_load_dwordx4 v[56:59], v8, s[32:35], s55 offen
    buffer_load_dwordx4 v[60:63], v8, s[32:35], s55 offen offset:1280
    s_waitcnt vmcnt(6)
    v_mfma_f32_32x32x16_bf16 v[16:31], v[32:35], v[36:39], v[16:31]
    s_add_u32 s55, s54, 30720
    buffer_load_dwordx4 v[32:35], v8, s[32:35], s55 offen
    buffer_load_dwordx4 v[36:39], v8, s[32:35], s55 offen offset:1280
    s_waitcnt vmcnt(6)
    v_mfma_f32_32x32x16_bf16 v[16:31], v[40:43], v[44:47], v[16:31]
    s_add_u32 s55, s54, 31360
    buffer_load_dwordx4 v[40:43], v8, s[32:35], s55 offen
    buffer_load_dwordx4 v[44:47], v8, s[32:35], s55 offen offset:1280
    s_waitcnt vmcnt(6)
    v_mfma_f32_32x32x16_bf16 v[16:31], v[48:51], v[52:55], v[16:31]
    s_add_u32 s55, s54, 33280
    buffer_load_dwordx4 v[48:51], v8, s[32:35], s55 offen
    buffer_load_dwordx4 v[52:55], v8, s[32:35], s55 offen offset:1280
    s_waitcnt vmcnt(6)
    v_mfma_f32_32x32x16_bf16 v[16:31], v[56:59], v[60:63], v[16:31]
    s_add_u32 s55, s54, 33920
    buffer_load_dwordx4 v[56:59], v8, s[32:35], s55 offen
    buffer_load_dwordx4 v[60:63], v8, s[32:35], s55 offen offset:1280
    s_waitcnt vmcnt(6)
    v_mfma_f32_32x32x16_bf16 v[16:31], v[32:35], v[36:39], v[16:31]
    s_add_u32 s55, s54, 35840
    buffer_load_dwordx4 v[32:35], v8, s[32:35], s55 offen
    buffer_load_dwordx4 v[36:39], v8, s[32:35], s55 offen offset:1280
    s_waitcnt vmcnt(6)
    v_mfma_f32_32x32x16_bf16 v[16:31], v[40:43], v[44:47], v[16:31]
    s_add_u32 s55, s54, 36480
    buffer_load_dwordx4 v[40:43], v8, s[32:35], s55 offen
    buffer_load_dwordx4 v[44:47], v8, s[32:35], s55 offen offset:1280
    s_waitcnt vmcnt(6)
    v_mfma_f32_32x32x16_bf16 v[16:31], v[48:51], v[52:55], v[16:31]
    s_add_u32 s55, s54, 38400
    buffer_load_dwordx4 v[48:51], v8, s[32:35], s55 offen
    buffer_load_dwordx4 v[52:55], v8, s[32:35], s55 offen offset:1280
    s_waitcnt vmcnt(6)
    v_mfma_f32_32x32x16_bf16 v[16:31], v[56:59], v[60:63], v[16:31]
    s_add_u32 s55, s54, 39040
    buffer_load_dwordx4 v[56:59], v8, s[32:35], s55 offen
    buffer_load_dwordx4 v[60:63], v8, s[32:35], s55 offen offset:1280
    s_waitcnt vmcnt(6)
    v_mfma_f32_32x32x16_bf16 v[16:31], v[32:35], v[36:39], v[16:31]
    s_waitcnt vmcnt(4)
    v_mfma_f32_32x32x16_bf16 v[16:31], v[40:43], v[44:47], v[16:31]
    s_waitcnt vmcnt(2)
    v_mfma_f32_32x32x16_bf16 v[16:31], v[48:51], v[52:55], v[16:31]
    s_waitcnt vmcnt(0)
    v_mfma_f32_32x32x16_bf16 v[16:31], v[56:59], v[60:63], v[16:31]
    s_mov_b64 exec, -1
    s_nop 7
    s_nop 7
    v_lshlrev_b32 v5, 4, v0
    s_lshl_b32 s44, s2, 2
    s_add_u32 s44, s44, s49
    s_mul_i32 s44, s44, 3072
    s_add_u32 s44, s44, 15728640
    buffer_store_dwordx4 v[16:19], v5, s[32:35], s44 offen
    buffer_store_dwordx4 v[20:23], v5, s[32:35], s44 offen offset:1024
    buffer_store_dwordx4 v[24:27], v5, s[32:35], s44 offen offset:2048
    s_waitcnt vmcnt(0)
    s_barrier
    s_mul_i32 s44, s2, 12288
    s_add_u32 s44, s44, 15728640
    s_add_u32 s55, s44, 0
    buffer_load_dwordx4 v[64:67], v5, s[32:35], s55 offen
    s_add_u32 s55, s44, 1024
    buffer_load_dwordx4 v[68:71], v5, s[32:35], s55 offen
    s_add_u32 s55, s44, 2048
    buffer_load_dwordx4 v[72:75], v5, s[32:35], s55 offen
    s_add_u32 s55, s44, 3072
    buffer_load_dwordx4 v[76:79], v5, s[32:35], s55 offen
    s_add_u32 s55, s44, 4096
    buffer_load_dwordx4 v[80:83], v5, s[32:35], s55 offen
    s_add_u32 s55, s44, 5120
    buffer_load_dwordx4 v[84:87], v5, s[32:35], s55 offen
    s_add_u32 s55, s44, 6144
    buffer_load_dwordx4 v[88:91], v5, s[32:35], s55 offen
    s_add_u32 s55, s44, 7168
    buffer_load_dwordx4 v[92:95], v5, s[32:35], s55 offen
    s_add_u32 s55, s44, 8192
    buffer_load_dwordx4 v[96:99], v5, s[32:35], s55 offen
    s_add_u32 s55, s44, 9216
    buffer_load_dwordx4 v[100:103], v5, s[32:35], s55 offen
    s_add_u32 s55, s44, 10240
    buffer_load_dwordx4 v[104:107], v5, s[32:35], s55 offen
    s_add_u32 s55, s44, 11264
    buffer_load_dwordx4 v[108:111], v5, s[32:35], s55 offen
    s_waitcnt vmcnt(0)
    v_add_f32 v16, v64, v76
    v_add_f32 v64, v88, v100
    v_add_f32 v17, v65, v77
    v_add_f32 v65, v89, v101
    v_add_f32 v18, v66, v78
    v_add_f32 v66, v90, v102
    v_add_f32 v19, v67, v79
    v_add_f32 v67, v91, v103
    v_add_f32 v20, v68, v80
    v_add_f32 v68, v92, v104
    v_add_f32 v21, v69, v81
    v_add_f32 v69, v93, v105
    v_add_f32 v22, v70, v82
    v_add_f32 v70, v94, v106
    v_add_f32 v23, v71, v83
    v_add_f32 v71, v95, v107
    v_add_f32 v24, v72, v84
    v_add_f32 v72, v96, v108
    v_add_f32 v25, v73, v85
    v_add_f32 v73, v97, v109
    v_add_f32 v26, v74, v86
    v_add_f32 v74, v98, v110
    v_add_f32 v27, v75, v87
    v_add_f32 v75, v99, v111
    v_add_f32 v16, v16, v64
    v_add_f32 v17, v17, v65
    v_add_f32 v18, v18, v66
    v_add_f32 v19, v19, v67
    v_add_f32 v20, v20, v68
    v_add_f32 v21, v21, v69
    v_add_f32 v22, v22, v70
    v_add_f32 v23, v23, v71
    v_add_f32 v24, v24, v72
    v_add_f32 v25, v25, v73
    v_add_f32 v26, v26, v74
    v_add_f32 v27, v27, v75
    v_cvt_pk_bf16_f32 v32, v16, v17
    v_cvt_pk_bf16_f32 v33, v18, v19
    v_cvt_pk_bf16_f32 v34, v20, v21
    v_cvt_pk_bf16_f32 v35, v22, v23
    v_cvt_pk_bf16_f32 v36, v24, v25
    v_cvt_pk_bf16_f32 v37, v26, v27
    s_nop 1
    v_mfma_f32_32x32x16_bf16 v[64:79], v[32:35], v[112:115], 0
    v_mfma_f32_32x32x8_bf16 v[64:79], v[36:37], v[116:117], v[64:79]
    v_mfma_f32_32x32x16_bf16 v[80:95], v[32:35], v[120:123], 0
    v_mfma_f32_32x32x8_bf16 v[80:95], v[36:37], v[124:125], v[80:95]
    s_nop 7
    s_nop 7
    v_mov_b32 v5, v72
    v_mov_b32 v7, v72
    s_mov_b32 s44, 897988541
    s_nop 0
    v_permlane32_swap_b32 v5, v7
    v_add_f32 v7, s44, v7
    v_rcp_f32 v7, v7
    s_nop 0
    v_mul_f32 v7, v7, v118
    v_mul_f32 v64, v64, v7
    v_mul_f32 v65, v65, v7
    v_mul_f32 v66, v66, v7
    v_mul_f32 v67, v67, v7
    v_mul_f32 v68, v68, v7
    v_mul_f32 v69, v69, v7
    v_mul_f32 v70, v70, v7
    v_mul_f32 v71, v71, v7
    v_mul_f32 v72, v72, v7
    v_mul_f32 v73, v73, v7
    v_mul_f32 v74, v74, v7
    v_mul_f32 v75, v75, v7
    v_cvt_pk_bf16_f32 v64, v64, v65
    v_cvt_pk_bf16_f32 v65, v66, v67
    v_cvt_pk_bf16_f32 v68, v68, v69
    v_cvt_pk_bf16_f32 v69, v70, v71
    v_cvt_pk_bf16_f32 v72, v72, v73
    v_cvt_pk_bf16_f32 v73, v74, v75
    s_add_u32 s55, s62, 0
    buffer_store_dwordx2 v[64:65], v14, s[32:35], s55 offen
    buffer_store_dwordx2 v[68:69], v14, s[32:35], s55 offen offset:1024
    buffer_store_dwordx2 v[72:73], v15, s[32:35], s55 offen
    v_mov_b32 v5, v88
    v_mov_b32 v7, v88
    s_mov_b32 s44, 897988541
    s_nop 0
    v_permlane32_swap_b32 v5, v7
    v_add_f32 v7, s44, v7
    v_rcp_f32 v7, v7
    s_nop 0
    v_mul_f32 v7, v7, v126
    v_mul_f32 v80, v80, v7
    v_mul_f32 v81, v81, v7
    v_mul_f32 v82, v82, v7
    v_mul_f32 v83, v83, v7
    v_mul_f32 v84, v84, v7
    v_mul_f32 v85, v85, v7
    v_mul_f32 v86, v86, v7
    v_mul_f32 v87, v87, v7
    v_mul_f32 v88, v88, v7
    v_mul_f32 v89, v89, v7
    v_mul_f32 v90, v90, v7
    v_mul_f32 v91, v91, v7
    v_cvt_pk_bf16_f32 v80, v80, v81
    v_cvt_pk_bf16_f32 v81, v82, v83
    v_cvt_pk_bf16_f32 v84, v84, v85
    v_cvt_pk_bf16_f32 v85, v86, v87
    v_cvt_pk_bf16_f32 v88, v88, v89
    v_cvt_pk_bf16_f32 v89, v90, v91
    s_add_u32 s55, s62, 256
    buffer_store_dwordx2 v[80:81], v14, s[32:35], s55 offen
    buffer_store_dwordx2 v[84:85], v14, s[32:35], s55 offen offset:1024
    buffer_store_dwordx2 v[88:89], v15, s[32:35], s55 offen
K2_done:
    s_endpgm
.globl oproj_kernel
.p2align 8
.type oproj_kernel,@function
oproj_kernel:
    s_cmp_ge_u32 s2, 256
    s_cbranch_scc1 K3_done
    s_load_dwordx2 s[18:19], s[0:1], 56
    s_load_dwordx4 s[20:23], s[0:1], 64
    s_and_b32 s40, s2, 7
    s_lshr_b32 s41, s2, 3
    s_lshr_b32 s42, s40, 1
    s_lshl_b32 s42, s42, 3
    s_and_b32 s43, s41, 7
    s_add_u32 s44, s42, s43
    s_and_b32 s42, s40, 1
    s_lshl_b32 s42, s42, 2
    s_lshr_b32 s43, s41, 3
    s_add_u32 s45, s42, s43
    v_lshrrev_b32 v1, 6, v0
    v_and_b32 v0, 63, v0
    s_nop 0
    v_readfirstlane_b32 s48, v1
    v_lshlrev_b32 v10, 4, v0
    s_waitcnt lgkmcnt(0)
    s_mov_b32 s32, s22
    s_and_b32 s33, s23, 0xffff
    s_mov_b32 s34, 28909568
    s_mov_b32 s35, 0x00020000
    s_mov_b32 s36, s18
    s_and_b32 s37, s19, 0xffff
    s_mov_b32 s38, 2621440
    s_mov_b32 s39, 0x00020000
    s_mul_i32 s50, s44, 163840
    s_mul_i32 s51, s48, 40960
    s_add_u32 s50, s50, s51
    s_add_u32 s50, s50, 23666688
    s_mul_i32 s52, s48, 40960
    s_lshr_b32 s53, s48, 1
    s_lshl_b32 s53, s53, 3
    s_add_u32 s53, s53, s45
    s_mul_i32 s53, s53, 20
    s_and_b32 s54, s48, 1
    s_mul_i32 s54, s54, 10
    s_add_u32 s53, s53, s54
    s_mul_i32 s53, s53, 5120
    s_add_u32 s53, s53, 22028288
    s_add_u32 m0, s52, 0
    s_add_u32 s55, s50, 0
    buffer_load_dwordx4 v10, s[32:35], s55 offen lds
    s_add_u32 m0, s52, 1024
    s_add_u32 s55, s50, 1024
    buffer_load_dwordx4 v10, s[32:35], s55 offen lds
    s_add_u32 m0, s52, 2048
    s_add_u32 s55, s50, 2048
    buffer_load_dwordx4 v10, s[32:35], s55 offen lds
    s_add_u32 m0, s52, 3072
    s_add_u32 s55, s50, 3072
    buffer_load_dwordx4 v10, s[32:35], s55 offen lds
    s_add_u32 m0, s52, 4096
    s_add_u32 s55, s50, 4096
    buffer_load_dwordx4 v10, s[32:35], s55 offen lds
    s_add_u32 m0, s52, 5120
    s_add_u32 s55, s50, 5120
    buffer_load_dwordx4 v10, s[32:35], s55 offen lds
    s_add_u32 m0, s52, 6144
    s_add_u32 s55, s50, 6144
    buffer_load_dwordx4 v10, s[32:35], s55 offen lds
    s_add_u32 m0, s52, 7168
    s_add_u32 s55, s50, 7168
    buffer_load_dwordx4 v10, s[32:35], s55 offen lds
    s_add_u32 s55, s53, 0
    buffer_load_dwordx4 v[96:99], v10, s[32:35], s55 offen
    s_add_u32 s55, s53, 1024
    buffer_load_dwordx4 v[100:103], v10, s[32:35], s55 offen
    s_add_u32 s55, s53, 2048
    buffer_load_dwordx4 v[104:107], v10, s[32:35], s55 offen
    s_add_u32 s55, s53, 3072
    buffer_load_dwordx4 v[108:111], v10, s[32:35], s55 offen
    s_add_u32 s55, s53, 4096
    buffer_load_dwordx4 v[112:115], v10, s[32:35], s55 offen
    s_add_u32 s55, s53, 5120
    buffer_load_dwordx4 v[116:119], v10, s[32:35], s55 offen
    s_add_u32 s55, s53, 6144
    buffer_load_dwordx4 v[120:123], v10, s[32:35], s55 offen
    s_add_u32 s55, s53, 7168
    buffer_load_dwordx4 v[124:127], v10, s[32:35], s55 offen
    s_add_u32 s55, s53, 8192
    buffer_load_dwordx4 v[128:131], v10, s[32:35], s55 offen
    s_add_u32 s55, s53, 9216
    buffer_load_dwordx4 v[132:135], v10, s[32:35], s55 offen
    s_add_u32 m0, s52, 8192
    s_add_u32 s55, s50, 8192
    buffer_load_dwordx4 v10, s[32:35], s55 offen lds
    s_add_u32 m0, s52, 9216
    s_add_u32 s55, s50, 9216
    buffer_load_dwordx4 v10, s[32:35], s55 offen lds
    s_add_u32 m0, s52, 10240
    s_add_u32 s55, s50, 10240
    buffer_load_dwordx4 v10, s[32:35], s55 offen lds
    s_add_u32 m0, s52, 11264
    s_add_u32 s55, s50, 11264
    buffer_load_dwordx4 v10, s[32:35], s55 offen lds
    s_add_u32 m0, s52, 12288
    s_add_u32 s55, s50, 12288
    buffer_load_dwordx4 v10, s[32:35], s55 offen lds
    s_add_u32 m0, s52, 13312
    s_add_u32 s55, s50, 13312
    buffer_load_dwordx4 v10, s[32:35], s55 offen lds
    s_add_u32 m0, s52, 14336
    s_add_u32 s55, s50, 14336
    buffer_load_dwordx4 v10, s[32:35], s55 offen lds
    s_add_u32 m0, s52, 15360
    s_add_u32 s55, s50, 15360
    buffer_load_dwordx4 v10, s[32:35], s55 offen lds
    s_add_u32 s55, s53, 10240
    buffer_load_dwordx4 v[136:139], v10, s[32:35], s55 offen
    s_add_u32 s55, s53, 11264
    buffer_load_dwordx4 v[140:143], v10, s[32:35], s55 offen
    s_add_u32 s55, s53, 12288
    buffer_load_dwordx4 v[144:147], v10, s[32:35], s55 offen
    s_add_u32 s55, s53, 13312
    buffer_load_dwordx4 v[148:151], v10, s[32:35], s55 offen
    s_add_u32 s55, s53, 14336
    buffer_load_dwordx4 v[152:155], v10, s[32:35], s55 offen
    s_add_u32 s55, s53, 15360
    buffer_load_dwordx4 v[156:159], v10, s[32:35], s55 offen
    s_add_u32 s55, s53, 16384
    buffer_load_dwordx4 v[160:163], v10, s[32:35], s55 offen
    s_add_u32 s55, s53, 17408
    buffer_load_dwordx4 v[164:167], v10, s[32:35], s55 offen
    s_add_u32 s55, s53, 18432
    buffer_load_dwordx4 v[168:171], v10, s[32:35], s55 offen
    s_add_u32 s55, s53, 19456
    buffer_load_dwordx4 v[172:175], v10, s[32:35], s55 offen
    s_add_u32 m0, s52, 16384
    s_add_u32 s55, s50, 16384
    buffer_load_dwordx4 v10, s[32:35], s55 offen lds
    s_add_u32 m0, s52, 17408
    s_add_u32 s55, s50, 17408
    buffer_load_dwordx4 v10, s[32:35], s55 offen lds
    s_add_u32 m0, s52, 18432
    s_add_u32 s55, s50, 18432
    buffer_load_dwordx4 v10, s[32:35], s55 offen lds
    s_add_u32 m0, s52, 19456
    s_add_u32 s55, s50, 19456
    buffer_load_dwordx4 v10, s[32:35], s55 offen lds
    s_add_u32 m0, s52, 20480
    s_add_u32 s55, s50, 20480
    buffer_load_dwordx4 v10, s[32:35], s55 offen lds
    s_add_u32 m0, s52, 21504
    s_add_u32 s55, s50, 21504
    buffer_load_dwordx4 v10, s[32:35], s55 offen lds
    s_add_u32 m0, s52, 22528
    s_add_u32 s55, s50, 22528
    buffer_load_dwordx4 v10, s[32:35], s55 offen lds
    s_add_u32 m0, s52, 23552
    s_add_u32 s55, s50, 23552
    buffer_load_dwordx4 v10, s[32:35], s55 offen lds
    s_add_u32 s55, s53, 20480
    buffer_load_dwordx4 v[176:179], v10, s[32:35], s55 offen
    s_add_u32 s55, s53, 21504
    buffer_load_dwordx4 v[180:183], v10, s[32:35], s55 offen
    s_add_u32 s55, s53, 22528
    buffer_load_dwordx4 v[184:187], v10, s[32:35], s55 offen
    s_add_u32 s55, s53, 23552
    buffer_load_dwordx4 v[188:191], v10, s[32:35], s55 offen
    s_add_u32 s55, s53, 24576
    buffer_load_dwordx4 v[192:195], v10, s[32:35], s55 offen
    s_add_u32 s55, s53, 25600
    buffer_load_dwordx4 v[196:199], v10, s[32:35], s55 offen
    s_add_u32 s55, s53, 26624
    buffer_load_dwordx4 v[200:203], v10, s[32:35], s55 offen
    s_add_u32 s55, s53, 27648
    buffer_load_dwordx4 v[204:207], v10, s[32:35], s55 offen
    s_add_u32 s55, s53, 28672
    buffer_load_dwordx4 v[208:211], v10, s[32:35], s55 offen
    s_add_u32 s55, s53, 29696
    buffer_load_dwordx4 v[212:215], v10, s[32:35], s55 offen
    s_add_u32 m0, s52, 24576
    s_add_u32 s55, s50, 24576
    buffer_load_dwordx4 v10, s[32:35], s55 offen lds
    s_add_u32 m0, s52, 25600
    s_add_u32 s55, s50, 25600
    buffer_load_dwordx4 v10, s[32:35], s55 offen lds
    s_add_u32 m0, s52, 26624
    s_add_u32 s55, s50, 26624
    buffer_load_dwordx4 v10, s[32:35], s55 offen lds
    s_add_u32 m0, s52, 27648
    s_add_u32 s55, s50, 27648
    buffer_load_dwordx4 v10, s[32:35], s55 offen lds
    s_add_u32 m0, s52, 28672
    s_add_u32 s55, s50, 28672
    buffer_load_dwordx4 v10, s[32:35], s55 offen lds
    s_add_u32 m0, s52, 29696
    s_add_u32 s55, s50, 29696
    buffer_load_dwordx4 v10, s[32:35], s55 offen lds
    s_add_u32 m0, s52, 30720
    s_add_u32 s55, s50, 30720
    buffer_load_dwordx4 v10, s[32:35], s55 offen lds
    s_add_u32 m0, s52, 31744
    s_add_u32 s55, s50, 31744
    buffer_load_dwordx4 v10, s[32:35], s55 offen lds
    v_mov_b32 v16, 0
    v_mov_b32 v17, 0
    v_mov_b32 v18, 0
    v_mov_b32 v19, 0
    v_mov_b32 v20, 0
    v_mov_b32 v21, 0
    v_mov_b32 v22, 0
    v_mov_b32 v23, 0
    v_mov_b32 v24, 0
    v_mov_b32 v25, 0
    v_mov_b32 v26, 0
    v_mov_b32 v27, 0
    v_mov_b32 v28, 0
    v_mov_b32 v29, 0
    v_mov_b32 v30, 0
    v_mov_b32 v31, 0
    v_mov_b32 v32, 0
    v_mov_b32 v33, 0
    v_mov_b32 v34, 0
    v_mov_b32 v35, 0
    v_mov_b32 v36, 0
    v_mov_b32 v37, 0
    v_mov_b32 v38, 0
    v_mov_b32 v39, 0
    v_mov_b32 v40, 0
    v_mov_b32 v41, 0
    v_mov_b32 v42, 0
    v_mov_b32 v43, 0
    v_mov_b32 v44, 0
    v_mov_b32 v45, 0
    v_mov_b32 v46, 0
    v_mov_b32 v47, 0
    v_mov_b32 v48, 0
    v_mov_b32 v49, 0
    v_mov_b32 v50, 0
    v_mov_b32 v51, 0
    v_mov_b32 v52, 0
    v_mov_b32 v53, 0
    v_mov_b32 v54, 0
    v_mov_b32 v55, 0
    v_mov_b32 v56, 0
    v_mov_b32 v57, 0
    v_mov_b32 v58, 0
    v_mov_b32 v59, 0
    v_mov_b32 v60, 0
    v_mov_b32 v61, 0
    v_mov_b32 v62, 0
    v_mov_b32 v63, 0
    v_mov_b32 v64, 0
    v_mov_b32 v65, 0
    v_mov_b32 v66, 0
    v_mov_b32 v67, 0
    v_mov_b32 v68, 0
    v_mov_b32 v69, 0
    v_mov_b32 v70, 0
    v_mov_b32 v71, 0
    v_mov_b32 v72, 0
    v_mov_b32 v73, 0
    v_mov_b32 v74, 0
    v_mov_b32 v75, 0
    v_mov_b32 v76, 0
    v_mov_b32 v77, 0
    v_mov_b32 v78, 0
    v_mov_b32 v79, 0
    v_mov_b32 v80, 0
    v_mov_b32 v81, 0
    v_mov_b32 v82, 0
    v_mov_b32 v83, 0
    v_mov_b32 v84, 0
    v_mov_b32 v85, 0
    v_mov_b32 v86, 0
    v_mov_b32 v87, 0
    v_mov_b32 v88, 0
    v_mov_b32 v89, 0
    v_mov_b32 v90, 0
    v_mov_b32 v91, 0
    v_mov_b32 v92, 0
    v_mov_b32 v93, 0
    v_mov_b32 v94, 0
    v_mov_b32 v95, 0
    v_and_b32 v1, 15, v0
    v_lshrrev_b32 v2, 4, v0
    v_lshlrev_b32 v3, 3, v1
    v_lshl_add_u32 v3, v2, 10, v3
    v_add_u32 v11, s52, v3
    s_waitcnt vmcnt(44)
    ds_read_b64 v[216:217], v11 offset:0
    ds_read_b64 v[218:219], v11 offset:512
    ds_read_b64 v[220:221], v11 offset:128
    ds_read_b64 v[222:223], v11 offset:640
    ds_read_b64 v[224:225], v11 offset:256
    ds_read_b64 v[226:227], v11 offset:768
    ds_read_b64 v[228:229], v11 offset:384
    ds_read_b64 v[230:231], v11 offset:896
    ds_read_b64 v[232:233], v11 offset:4096
    ds_read_b64 v[234:235], v11 offset:4608
    ds_read_b64 v[236:237], v11 offset:4224
    ds_read_b64 v[238:239], v11 offset:4736
    ds_read_b64 v[240:241], v11 offset:4352
    ds_read_b64 v[242:243], v11 offset:4864
    ds_read_b64 v[244:245], v11 offset:4480
    ds_read_b64 v[246:247], v11 offset:4992
    s_waitcnt lgkmcnt(8)
    v_mfma_f32_16x16x32_bf16 v[16:19], v[96:99], v[216:219], v[16:19]
    v_mfma_f32_16x16x32_bf16 v[36:39], v[96:99], v[220:223], v[36:39]
    v_mfma_f32_16x16x32_bf16 v[56:59], v[96:99], v[224:227], v[56:59]
    v_mfma_f32_16x16x32_bf16 v[76:79], v[96:99], v[228:231], v[76:79]
    v_mfma_f32_16x16x32_bf16 v[20:23], v[100:103], v[216:219], v[20:23]
    v_mfma_f32_16x16x32_bf16 v[40:43], v[100:103], v[220:223], v[40:43]
    v_mfma_f32_16x16x32_bf16 v[60:63], v[100:103], v[224:227], v[60:63]
    v_mfma_f32_16x16x32_bf16 v[80:83], v[100:103], v[228:231], v[80:83]
    v_mfma_f32_16x16x32_bf16 v[24:27], v[104:107], v[216:219], v[24:27]
    v_mfma_f32_16x16x32_bf16 v[44:47], v[104:107], v[220:223], v[44:47]
    v_mfma_f32_16x16x32_bf16 v[64:67], v[104:107], v[224:227], v[64:67]
    v_mfma_f32_16x16x32_bf16 v[84:87], v[104:107], v[228:231], v[84:87]
    v_mfma_f32_16x16x32_bf16 v[28:31], v[108:111], v[216:219], v[28:31]
    v_mfma_f32_16x16x32_bf16 v[48:51], v[108:111], v[220:223], v[48:51]
    v_mfma_f32_16x16x32_bf16 v[68:71], v[108:111], v[224:227], v[68:71]
    v_mfma_f32_16x16x32_bf16 v[88:91], v[108:111], v[228:231], v[88:91]
    v_mfma_f32_16x16x32_bf16 v[32:35], v[112:115], v[216:219], v[32:35]
    v_mfma_f32_16x16x32_bf16 v[52:55], v[112:115], v[220:223], v[52:55]
    v_mfma_f32_16x16x32_bf16 v[72:75], v[112:115], v[224:227], v[72:75]
    v_mfma_f32_16x16x32_bf16 v[92:95], v[112:115], v[228:231], v[92:95]
    s_waitcnt lgkmcnt(0)
    v_mfma_f32_16x16x32_bf16 v[16:19], v[116:119], v[232:235], v[16:19]
    v_mfma_f32_16x16x32_bf16 v[36:39], v[116:119], v[236:239], v[36:39]
    v_mfma_f32_16x16x32_bf16 v[56:59], v[116:119], v[240:243], v[56:59]
    v_mfma_f32_16x16x32_bf16 v[76:79], v[116:119], v[244:247], v[76:79]
    v_mfma_f32_16x16x32_bf16 v[20:23], v[120:123], v[232:235], v[20:23]
    v_mfma_f32_16x16x32_bf16 v[40:43], v[120:123], v[236:239], v[40:43]
    v_mfma_f32_16x16x32_bf16 v[60:63], v[120:123], v[240:243], v[60:63]
    v_mfma_f32_16x16x32_bf16 v[80:83], v[120:123], v[244:247], v[80:83]
    v_mfma_f32_16x16x32_bf16 v[24:27], v[124:127], v[232:235], v[24:27]
    v_mfma_f32_16x16x32_bf16 v[44:47], v[124:127], v[236:239], v[44:47]
    v_mfma_f32_16x16x32_bf16 v[64:67], v[124:127], v[240:243], v[64:67]
    v_mfma_f32_16x16x32_bf16 v[84:87], v[124:127], v[244:247], v[84:87]
    v_mfma_f32_16x16x32_bf16 v[28:31], v[128:131], v[232:235], v[28:31]
    v_mfma_f32_16x16x32_bf16 v[48:51], v[128:131], v[236:239], v[48:51]
    v_mfma_f32_16x16x32_bf16 v[68:71], v[128:131], v[240:243], v[68:71]
    v_mfma_f32_16x16x32_bf16 v[88:91], v[128:131], v[244:247], v[88:91]
    v_mfma_f32_16x16x32_bf16 v[32:35], v[132:135], v[232:235], v[32:35]
    v_mfma_f32_16x16x32_bf16 v[52:55], v[132:135], v[236:239], v[52:55]
    v_mfma_f32_16x16x32_bf16 v[72:75], v[132:135], v[240:243], v[72:75]
    v_mfma_f32_16x16x32_bf16 v[92:95], v[132:135], v[244:247], v[92:95]
    s_add_u32 m0, s52, 32768
    s_add_u32 s55, s50, 32768
    buffer_load_dwordx4 v10, s[32:35], s55 offen lds
    s_add_u32 m0, s52, 33792
    s_add_u32 s55, s50, 33792
    buffer_load_dwordx4 v10, s[32:35], s55 offen lds
    s_add_u32 m0, s52, 34816
    s_add_u32 s55, s50, 34816
    buffer_load_dwordx4 v10, s[32:35], s55 offen lds
    s_add_u32 m0, s52, 35840
    s_add_u32 s55, s50, 35840
    buffer_load_dwordx4 v10, s[32:35], s55 offen lds
    s_add_u32 m0, s52, 36864
    s_add_u32 s55, s50, 36864
    buffer_load_dwordx4 v10, s[32:35], s55 offen lds
    s_add_u32 m0, s52, 37888
    s_add_u32 s55, s50, 37888
    buffer_load_dwordx4 v10, s[32:35], s55 offen lds
    s_add_u32 m0, s52, 38912
    s_add_u32 s55, s50, 38912
    buffer_load_dwordx4 v10, s[32:35], s55 offen lds
    s_add_u32 m0, s52, 39936
    s_add_u32 s55, s50, 39936
    buffer_load_dwordx4 v10, s[32:35], s55 offen lds
    s_add_u32 s55, s53, 30720
    buffer_load_dwordx4 v[96:99], v10, s[32:35], s55 offen
    s_add_u32 s55, s53, 31744
    buffer_load_dwordx4 v[100:103], v10, s[32:35], s55 offen
    s_add_u32 s55, s53, 32768
    buffer_load_dwordx4 v[104:107], v10, s[32:35], s55 offen
    s_add_u32 s55, s53, 33792
    buffer_load_dwordx4 v[108:111], v10, s[32:35], s55 offen
    s_add_u32 s55, s53, 34816
    buffer_load_dwordx4 v[112:115], v10, s[32:35], s55 offen
    s_add_u32 s55, s53, 35840
    buffer_load_dwordx4 v[116:119], v10, s[32:35], s55 offen
    s_add_u32 s55, s53, 36864
    buffer_load_dwordx4 v[120:123], v10, s[32:35], s55 offen
    s_add_u32 s55, s53, 37888
    buffer_load_dwordx4 v[124:127], v10, s[32:35], s55 offen
    s_add_u32 s55, s53, 38912
    buffer_load_dwordx4 v[128:131], v10, s[32:35], s55 offen
    s_add_u32 s55, s53, 39936
    buffer_load_dwordx4 v[132:135], v10, s[32:35], s55 offen
    s_waitcnt vmcnt(44)
    ds_read_b64 v[216:217], v11 offset:8192
    ds_read_b64 v[218:219], v11 offset:8704
    ds_read_b64 v[220:221], v11 offset:8320
    ds_read_b64 v[222:223], v11 offset:8832
    ds_read_b64 v[224:225], v11 offset:8448
    ds_read_b64 v[226:227], v11 offset:8960
    ds_read_b64 v[228:229], v11 offset:8576
    ds_read_b64 v[230:231], v11 offset:9088
    ds_read_b64 v[232:233], v11 offset:12288
    ds_read_b64 v[234:235], v11 offset:12800
    ds_read_b64 v[236:237], v11 offset:12416
    ds_read_b64 v[238:239], v11 offset:12928
    ds_read_b64 v[240:241], v11 offset:12544
    ds_read_b64 v[242:243], v11 offset:13056
    ds_read_b64 v[244:245], v11 offset:12672
    ds_read_b64 v[246:247], v11 offset:13184
    s_waitcnt lgkmcnt(8)
    v_mfma_f32_16x16x32_bf16 v[16:19], v[136:139], v[216:219], v[16:19]
    v_mfma_f32_16x16x32_bf16 v[36:39], v[136:139], v[220:223], v[36:39]
    v_mfma_f32_16x16x32_bf16 v[56:59], v[136:139], v[224:227], v[56:59]
    v_mfma_f32_16x16x32_bf16 v[76:79], v[136:139], v[228:231], v[76:79]
    v_mfma_f32_16x16x32_bf16 v[20:23], v[140:143], v[216:219], v[20:23]
    v_mfma_f32_16x16x32_bf16 v[40:43], v[140:143], v[220:223], v[40:43]
    v_mfma_f32_16x16x32_bf16 v[60:63], v[140:143], v[224:227], v[60:63]
    v_mfma_f32_16x16x32_bf16 v[80:83], v[140:143], v[228:231], v[80:83]
    v_mfma_f32_16x16x32_bf16 v[24:27], v[144:147], v[216:219], v[24:27]
    v_mfma_f32_16x16x32_bf16 v[44:47], v[144:147], v[220:223], v[44:47]
    v_mfma_f32_16x16x32_bf16 v[64:67], v[144:147], v[224:227], v[64:67]
    v_mfma_f32_16x16x32_bf16 v[84:87], v[144:147], v[228:231], v[84:87]
    v_mfma_f32_16x16x32_bf16 v[28:31], v[148:151], v[216:219], v[28:31]
    v_mfma_f32_16x16x32_bf16 v[48:51], v[148:151], v[220:223], v[48:51]
    v_mfma_f32_16x16x32_bf16 v[68:71], v[148:151], v[224:227], v[68:71]
    v_mfma_f32_16x16x32_bf16 v[88:91], v[148:151], v[228:231], v[88:91]
    v_mfma_f32_16x16x32_bf16 v[32:35], v[152:155], v[216:219], v[32:35]
    v_mfma_f32_16x16x32_bf16 v[52:55], v[152:155], v[220:223], v[52:55]
    v_mfma_f32_16x16x32_bf16 v[72:75], v[152:155], v[224:227], v[72:75]
    v_mfma_f32_16x16x32_bf16 v[92:95], v[152:155], v[228:231], v[92:95]
    s_waitcnt lgkmcnt(0)
    v_mfma_f32_16x16x32_bf16 v[16:19], v[156:159], v[232:235], v[16:19]
    v_mfma_f32_16x16x32_bf16 v[36:39], v[156:159], v[236:239], v[36:39]
    v_mfma_f32_16x16x32_bf16 v[56:59], v[156:159], v[240:243], v[56:59]
    v_mfma_f32_16x16x32_bf16 v[76:79], v[156:159], v[244:247], v[76:79]
    v_mfma_f32_16x16x32_bf16 v[20:23], v[160:163], v[232:235], v[20:23]
    v_mfma_f32_16x16x32_bf16 v[40:43], v[160:163], v[236:239], v[40:43]
    v_mfma_f32_16x16x32_bf16 v[60:63], v[160:163], v[240:243], v[60:63]
    v_mfma_f32_16x16x32_bf16 v[80:83], v[160:163], v[244:247], v[80:83]
    v_mfma_f32_16x16x32_bf16 v[24:27], v[164:167], v[232:235], v[24:27]
    v_mfma_f32_16x16x32_bf16 v[44:47], v[164:167], v[236:239], v[44:47]
    v_mfma_f32_16x16x32_bf16 v[64:67], v[164:167], v[240:243], v[64:67]
    v_mfma_f32_16x16x32_bf16 v[84:87], v[164:167], v[244:247], v[84:87]
    v_mfma_f32_16x16x32_bf16 v[28:31], v[168:171], v[232:235], v[28:31]
    v_mfma_f32_16x16x32_bf16 v[48:51], v[168:171], v[236:239], v[48:51]
    v_mfma_f32_16x16x32_bf16 v[68:71], v[168:171], v[240:243], v[68:71]
    v_mfma_f32_16x16x32_bf16 v[88:91], v[168:171], v[244:247], v[88:91]
    v_mfma_f32_16x16x32_bf16 v[32:35], v[172:175], v[232:235], v[32:35]
    v_mfma_f32_16x16x32_bf16 v[52:55], v[172:175], v[236:239], v[52:55]
    v_mfma_f32_16x16x32_bf16 v[72:75], v[172:175], v[240:243], v[72:75]
    v_mfma_f32_16x16x32_bf16 v[92:95], v[172:175], v[244:247], v[92:95]
    s_add_u32 s55, s53, 40960
    buffer_load_dwordx4 v[136:139], v10, s[32:35], s55 offen
    s_add_u32 s55, s53, 41984
    buffer_load_dwordx4 v[140:143], v10, s[32:35], s55 offen
    s_add_u32 s55, s53, 43008
    buffer_load_dwordx4 v[144:147], v10, s[32:35], s55 offen
    s_add_u32 s55, s53, 44032
    buffer_load_dwordx4 v[148:151], v10, s[32:35], s55 offen
    s_add_u32 s55, s53, 45056
    buffer_load_dwordx4 v[152:155], v10, s[32:35], s55 offen
    s_add_u32 s55, s53, 46080
    buffer_load_dwordx4 v[156:159], v10, s[32:35], s55 offen
    s_add_u32 s55, s53, 47104
    buffer_load_dwordx4 v[160:163], v10, s[32:35], s55 offen
    s_add_u32 s55, s53, 48128
    buffer_load_dwordx4 v[164:167], v10, s[32:35], s55 offen
    s_add_u32 s55, s53, 49152
    buffer_load_dwordx4 v[168:171], v10, s[32:35], s55 offen
    s_add_u32 s55, s53, 50176
    buffer_load_dwordx4 v[172:175], v10, s[32:35], s55 offen
    s_waitcnt vmcnt(36)
    ds_read_b64 v[216:217], v11 offset:16384
    ds_read_b64 v[218:219], v11 offset:16896
    ds_read_b64 v[220:221], v11 offset:16512
    ds_read_b64 v[222:223], v11 offset:17024
    ds_read_b64 v[224:225], v11 offset:16640
    ds_read_b64 v[226:227], v11 offset:17152
    ds_read_b64 v[228:229], v11 offset:16768
    ds_read_b64 v[230:231], v11 offset:17280
    ds_read_b64 v[232:233], v11 offset:20480
    ds_read_b64 v[234:235], v11 offset:20992
    ds_read_b64 v[236:237], v11 offset:20608
    ds_read_b64 v[238:239], v11 offset:21120
    ds_read_b64 v[240:241], v11 offset:20736
    ds_read_b64 v[242:243], v11 offset:21248
    ds_read_b64 v[244:245], v11 offset:20864
    ds_read_b64 v[246:247], v11 offset:21376
    s_waitcnt lgkmcnt(8)
    v_mfma_f32_16x16x32_bf16 v[16:19], v[176:179], v[216:219], v[16:19]
    v_mfma_f32_16x16x32_bf16 v[36:39], v[176:179], v[220:223], v[36:39]
    v_mfma_f32_16x16x32_bf16 v[56:59], v[176:179], v[224:227], v[56:59]
    v_mfma_f32_16x16x32_bf16 v[76:79], v[176:179], v[228:231], v[76:79]
    v_mfma_f32_16x16x32_bf16 v[20:23], v[180:183], v[216:219], v[20:23]
    v_mfma_f32_16x16x32_bf16 v[40:43], v[180:183], v[220:223], v[40:43]
    v_mfma_f32_16x16x32_bf16 v[60:63], v[180:183], v[224:227], v[60:63]
    v_mfma_f32_16x16x32_bf16 v[80:83], v[180:183], v[228:231], v[80:83]
    v_mfma_f32_16x16x32_bf16 v[24:27], v[184:187], v[216:219], v[24:27]
    v_mfma_f32_16x16x32_bf16 v[44:47], v[184:187], v[220:223], v[44:47]
    v_mfma_f32_16x16x32_bf16 v[64:67], v[184:187], v[224:227], v[64:67]
    v_mfma_f32_16x16x32_bf16 v[84:87], v[184:187], v[228:231], v[84:87]
    v_mfma_f32_16x16x32_bf16 v[28:31], v[188:191], v[216:219], v[28:31]
    v_mfma_f32_16x16x32_bf16 v[48:51], v[188:191], v[220:223], v[48:51]
    v_mfma_f32_16x16x32_bf16 v[68:71], v[188:191], v[224:227], v[68:71]
    v_mfma_f32_16x16x32_bf16 v[88:91], v[188:191], v[228:231], v[88:91]
    v_mfma_f32_16x16x32_bf16 v[32:35], v[192:195], v[216:219], v[32:35]
    v_mfma_f32_16x16x32_bf16 v[52:55], v[192:195], v[220:223], v[52:55]
    v_mfma_f32_16x16x32_bf16 v[72:75], v[192:195], v[224:227], v[72:75]
    v_mfma_f32_16x16x32_bf16 v[92:95], v[192:195], v[228:231], v[92:95]
    s_waitcnt lgkmcnt(0)
    v_mfma_f32_16x16x32_bf16 v[16:19], v[196:199], v[232:235], v[16:19]
    v_mfma_f32_16x16x32_bf16 v[36:39], v[196:199], v[236:239], v[36:39]
    v_mfma_f32_16x16x32_bf16 v[56:59], v[196:199], v[240:243], v[56:59]
    v_mfma_f32_16x16x32_bf16 v[76:79], v[196:199], v[244:247], v[76:79]
    v_mfma_f32_16x16x32_bf16 v[20:23], v[200:203], v[232:235], v[20:23]
    v_mfma_f32_16x16x32_bf16 v[40:43], v[200:203], v[236:239], v[40:43]
    v_mfma_f32_16x16x32_bf16 v[60:63], v[200:203], v[240:243], v[60:63]
    v_mfma_f32_16x16x32_bf16 v[80:83], v[200:203], v[244:247], v[80:83]
    v_mfma_f32_16x16x32_bf16 v[24:27], v[204:207], v[232:235], v[24:27]
    v_mfma_f32_16x16x32_bf16 v[44:47], v[204:207], v[236:239], v[44:47]
    v_mfma_f32_16x16x32_bf16 v[64:67], v[204:207], v[240:243], v[64:67]
    v_mfma_f32_16x16x32_bf16 v[84:87], v[204:207], v[244:247], v[84:87]
    v_mfma_f32_16x16x32_bf16 v[28:31], v[208:211], v[232:235], v[28:31]
    v_mfma_f32_16x16x32_bf16 v[48:51], v[208:211], v[236:239], v[48:51]
    v_mfma_f32_16x16x32_bf16 v[68:71], v[208:211], v[240:243], v[68:71]
    v_mfma_f32_16x16x32_bf16 v[88:91], v[208:211], v[244:247], v[88:91]
    v_mfma_f32_16x16x32_bf16 v[32:35], v[212:215], v[232:235], v[32:35]
    v_mfma_f32_16x16x32_bf16 v[52:55], v[212:215], v[236:239], v[52:55]
    v_mfma_f32_16x16x32_bf16 v[72:75], v[212:215], v[240:243], v[72:75]
    v_mfma_f32_16x16x32_bf16 v[92:95], v[212:215], v[244:247], v[92:95]
    s_waitcnt vmcnt(10)
    ds_read_b64 v[216:217], v11 offset:24576
    ds_read_b64 v[218:219], v11 offset:25088
    ds_read_b64 v[220:221], v11 offset:24704
    ds_read_b64 v[222:223], v11 offset:25216
    ds_read_b64 v[224:225], v11 offset:24832
    ds_read_b64 v[226:227], v11 offset:25344
    ds_read_b64 v[228:229], v11 offset:24960
    ds_read_b64 v[230:231], v11 offset:25472
    ds_read_b64 v[232:233], v11 offset:28672
    ds_read_b64 v[234:235], v11 offset:29184
    ds_read_b64 v[236:237], v11 offset:28800
    ds_read_b64 v[238:239], v11 offset:29312
    ds_read_b64 v[240:241], v11 offset:28928
    ds_read_b64 v[242:243], v11 offset:29440
    ds_read_b64 v[244:245], v11 offset:29056
    ds_read_b64 v[246:247], v11 offset:29568
    s_waitcnt lgkmcnt(8)
    v_mfma_f32_16x16x32_bf16 v[16:19], v[96:99], v[216:219], v[16:19]
    v_mfma_f32_16x16x32_bf16 v[36:39], v[96:99], v[220:223], v[36:39]
    v_mfma_f32_16x16x32_bf16 v[56:59], v[96:99], v[224:227], v[56:59]
    v_mfma_f32_16x16x32_bf16 v[76:79], v[96:99], v[228:231], v[76:79]
    v_mfma_f32_16x16x32_bf16 v[20:23], v[100:103], v[216:219], v[20:23]
    v_mfma_f32_16x16x32_bf16 v[40:43], v[100:103], v[220:223], v[40:43]
    v_mfma_f32_16x16x32_bf16 v[60:63], v[100:103], v[224:227], v[60:63]
    v_mfma_f32_16x16x32_bf16 v[80:83], v[100:103], v[228:231], v[80:83]
    v_mfma_f32_16x16x32_bf16 v[24:27], v[104:107], v[216:219], v[24:27]
    v_mfma_f32_16x16x32_bf16 v[44:47], v[104:107], v[220:223], v[44:47]
    v_mfma_f32_16x16x32_bf16 v[64:67], v[104:107], v[224:227], v[64:67]
    v_mfma_f32_16x16x32_bf16 v[84:87], v[104:107], v[228:231], v[84:87]
    v_mfma_f32_16x16x32_bf16 v[28:31], v[108:111], v[216:219], v[28:31]
    v_mfma_f32_16x16x32_bf16 v[48:51], v[108:111], v[220:223], v[48:51]
    v_mfma_f32_16x16x32_bf16 v[68:71], v[108:111], v[224:227], v[68:71]
    v_mfma_f32_16x16x32_bf16 v[88:91], v[108:111], v[228:231], v[88:91]
    v_mfma_f32_16x16x32_bf16 v[32:35], v[112:115], v[216:219], v[32:35]
    v_mfma_f32_16x16x32_bf16 v[52:55], v[112:115], v[220:223], v[52:55]
    v_mfma_f32_16x16x32_bf16 v[72:75], v[112:115], v[224:227], v[72:75]
    v_mfma_f32_16x16x32_bf16 v[92:95], v[112:115], v[228:231], v[92:95]
    s_waitcnt lgkmcnt(0)
    v_mfma_f32_16x16x32_bf16 v[16:19], v[116:119], v[232:235], v[16:19]
    v_mfma_f32_16x16x32_bf16 v[36:39], v[116:119], v[236:239], v[36:39]
    v_mfma_f32_16x16x32_bf16 v[56:59], v[116:119], v[240:243], v[56:59]
    v_mfma_f32_16x16x32_bf16 v[76:79], v[116:119], v[244:247], v[76:79]
    v_mfma_f32_16x16x32_bf16 v[20:23], v[120:123], v[232:235], v[20:23]
    v_mfma_f32_16x16x32_bf16 v[40:43], v[120:123], v[236:239], v[40:43]
    v_mfma_f32_16x16x32_bf16 v[60:63], v[120:123], v[240:243], v[60:63]
    v_mfma_f32_16x16x32_bf16 v[80:83], v[120:123], v[244:247], v[80:83]
    v_mfma_f32_16x16x32_bf16 v[24:27], v[124:127], v[232:235], v[24:27]
    v_mfma_f32_16x16x32_bf16 v[44:47], v[124:127], v[236:239], v[44:47]
    v_mfma_f32_16x16x32_bf16 v[64:67], v[124:127], v[240:243], v[64:67]
    v_mfma_f32_16x16x32_bf16 v[84:87], v[124:127], v[244:247], v[84:87]
    v_mfma_f32_16x16x32_bf16 v[28:31], v[128:131], v[232:235], v[28:31]
    v_mfma_f32_16x16x32_bf16 v[48:51], v[128:131], v[236:239], v[48:51]
    v_mfma_f32_16x16x32_bf16 v[68:71], v[128:131], v[240:243], v[68:71]
    v_mfma_f32_16x16x32_bf16 v[88:91], v[128:131], v[244:247], v[88:91]
    v_mfma_f32_16x16x32_bf16 v[32:35], v[132:135], v[232:235], v[32:35]
    v_mfma_f32_16x16x32_bf16 v[52:55], v[132:135], v[236:239], v[52:55]
    v_mfma_f32_16x16x32_bf16 v[72:75], v[132:135], v[240:243], v[72:75]
    v_mfma_f32_16x16x32_bf16 v[92:95], v[132:135], v[244:247], v[92:95]
    s_waitcnt vmcnt(0)
    ds_read_b64 v[216:217], v11 offset:32768
    ds_read_b64 v[218:219], v11 offset:33280
    ds_read_b64 v[220:221], v11 offset:32896
    ds_read_b64 v[222:223], v11 offset:33408
    ds_read_b64 v[224:225], v11 offset:33024
    ds_read_b64 v[226:227], v11 offset:33536
    ds_read_b64 v[228:229], v11 offset:33152
    ds_read_b64 v[230:231], v11 offset:33664
    ds_read_b64 v[232:233], v11 offset:36864
    ds_read_b64 v[234:235], v11 offset:37376
    ds_read_b64 v[236:237], v11 offset:36992
    ds_read_b64 v[238:239], v11 offset:37504
    ds_read_b64 v[240:241], v11 offset:37120
    ds_read_b64 v[242:243], v11 offset:37632
    ds_read_b64 v[244:245], v11 offset:37248
    ds_read_b64 v[246:247], v11 offset:37760
    s_waitcnt lgkmcnt(8)
    v_mfma_f32_16x16x32_bf16 v[16:19], v[136:139], v[216:219], v[16:19]
    v_mfma_f32_16x16x32_bf16 v[36:39], v[136:139], v[220:223], v[36:39]
    v_mfma_f32_16x16x32_bf16 v[56:59], v[136:139], v[224:227], v[56:59]
    v_mfma_f32_16x16x32_bf16 v[76:79], v[136:139], v[228:231], v[76:79]
    v_mfma_f32_16x16x32_bf16 v[20:23], v[140:143], v[216:219], v[20:23]
    v_mfma_f32_16x16x32_bf16 v[40:43], v[140:143], v[220:223], v[40:43]
    v_mfma_f32_16x16x32_bf16 v[60:63], v[140:143], v[224:227], v[60:63]
    v_mfma_f32_16x16x32_bf16 v[80:83], v[140:143], v[228:231], v[80:83]
    v_mfma_f32_16x16x32_bf16 v[24:27], v[144:147], v[216:219], v[24:27]
    v_mfma_f32_16x16x32_bf16 v[44:47], v[144:147], v[220:223], v[44:47]
    v_mfma_f32_16x16x32_bf16 v[64:67], v[144:147], v[224:227], v[64:67]
    v_mfma_f32_16x16x32_bf16 v[84:87], v[144:147], v[228:231], v[84:87]
    v_mfma_f32_16x16x32_bf16 v[28:31], v[148:151], v[216:219], v[28:31]
    v_mfma_f32_16x16x32_bf16 v[48:51], v[148:151], v[220:223], v[48:51]
    v_mfma_f32_16x16x32_bf16 v[68:71], v[148:151], v[224:227], v[68:71]
    v_mfma_f32_16x16x32_bf16 v[88:91], v[148:151], v[228:231], v[88:91]
    v_mfma_f32_16x16x32_bf16 v[32:35], v[152:155], v[216:219], v[32:35]
    v_mfma_f32_16x16x32_bf16 v[52:55], v[152:155], v[220:223], v[52:55]
    v_mfma_f32_16x16x32_bf16 v[72:75], v[152:155], v[224:227], v[72:75]
    v_mfma_f32_16x16x32_bf16 v[92:95], v[152:155], v[228:231], v[92:95]
    s_waitcnt lgkmcnt(0)
    v_mfma_f32_16x16x32_bf16 v[16:19], v[156:159], v[232:235], v[16:19]
    v_mfma_f32_16x16x32_bf16 v[36:39], v[156:159], v[236:239], v[36:39]
    v_mfma_f32_16x16x32_bf16 v[56:59], v[156:159], v[240:243], v[56:59]
    v_mfma_f32_16x16x32_bf16 v[76:79], v[156:159], v[244:247], v[76:79]
    v_mfma_f32_16x16x32_bf16 v[20:23], v[160:163], v[232:235], v[20:23]
    v_mfma_f32_16x16x32_bf16 v[40:43], v[160:163], v[236:239], v[40:43]
    v_mfma_f32_16x16x32_bf16 v[60:63], v[160:163], v[240:243], v[60:63]
    v_mfma_f32_16x16x32_bf16 v[80:83], v[160:163], v[244:247], v[80:83]
    v_mfma_f32_16x16x32_bf16 v[24:27], v[164:167], v[232:235], v[24:27]
    v_mfma_f32_16x16x32_bf16 v[44:47], v[164:167], v[236:239], v[44:47]
    v_mfma_f32_16x16x32_bf16 v[64:67], v[164:167], v[240:243], v[64:67]
    v_mfma_f32_16x16x32_bf16 v[84:87], v[164:167], v[244:247], v[84:87]
    v_mfma_f32_16x16x32_bf16 v[28:31], v[168:171], v[232:235], v[28:31]
    v_mfma_f32_16x16x32_bf16 v[48:51], v[168:171], v[236:239], v[48:51]
    v_mfma_f32_16x16x32_bf16 v[68:71], v[168:171], v[240:243], v[68:71]
    v_mfma_f32_16x16x32_bf16 v[88:91], v[168:171], v[244:247], v[88:91]
    v_mfma_f32_16x16x32_bf16 v[32:35], v[172:175], v[232:235], v[32:35]
    v_mfma_f32_16x16x32_bf16 v[52:55], v[172:175], v[236:239], v[52:55]
    v_mfma_f32_16x16x32_bf16 v[72:75], v[172:175], v[240:243], v[72:75]
    v_mfma_f32_16x16x32_bf16 v[92:95], v[172:175], v[244:247], v[92:95]
    s_nop 7
    s_nop 7
    v_add_u32 v3, s52, v10
    s_lshl_b32 s55, s44, 6
    s_lshl_b32 s56, s48, 4
    s_add_u32 s55, s55, s56
    v_add_u32 v4, s55, v1
    v_mul_u32_u24 v4, 1280, v4
    v_lshl_add_u32 v4, v2, 3, v4
    s_mul_i32 s55, s45, 160
K3_red0:
    s_cmp_lg_u32 s48, 0
    s_cbranch_scc1 K3_red1
    ds_write_b128 v3, v[36:39] offset:5120
    ds_write_b128 v3, v[40:43] offset:6144
    ds_write_b128 v3, v[44:47] offset:7168
    ds_write_b128 v3, v[48:51] offset:8192
    ds_write_b128 v3, v[52:55] offset:9216
    ds_write_b128 v3, v[56:59] offset:10240
    ds_write_b128 v3, v[60:63] offset:11264
    ds_write_b128 v3, v[64:67] offset:12288
    ds_write_b128 v3, v[68:71] offset:13312
    ds_write_b128 v3, v[72:75] offset:14336
    ds_write_b128 v3, v[76:79] offset:15360
    ds_write_b128 v3, v[80:83] offset:16384
    ds_write_b128 v3, v[84:87] offset:17408
    ds_write_b128 v3, v[88:91] offset:18432
    ds_write_b128 v3, v[92:95] offset:19456
    s_waitcnt lgkmcnt(0)
    s_barrier
    v_add_u32 v5, 40960, v10
    v_add_u32 v6, 81920, v10
    v_add_u32 v7, 122880, v10
    ds_read_b128 v[96:99], v5 offset:0
    ds_read_b128 v[100:103], v6 offset:0
    ds_read_b128 v[104:107], v7 offset:0
    ds_read_b128 v[108:111], v5 offset:1024
    ds_read_b128 v[112:115], v6 offset:1024
    ds_read_b128 v[116:119], v7 offset:1024
    ds_read_b128 v[120:123], v5 offset:2048
    ds_read_b128 v[124:127], v6 offset:2048
    ds_read_b128 v[128:131], v7 offset:2048
    ds_read_b128 v[132:135], v5 offset:3072
    ds_read_b128 v[136:139], v6 offset:3072
    ds_read_b128 v[140:143], v7 offset:3072
    ds_read_b128 v[144:147], v5 offset:4096
    ds_read_b128 v[148:151], v6 offset:4096
    ds_read_b128 v[152:155], v7 offset:4096
    s_waitcnt lgkmcnt(12)
    v_pk_add_f32 v[16:17], v[16:17], v[96:97]
    v_pk_add_f32 v[100:101], v[100:101], v[104:105]
    v_pk_add_f32 v[18:19], v[18:19], v[98:99]
    v_pk_add_f32 v[102:103], v[102:103], v[106:107]
    v_pk_add_f32 v[16:17], v[16:17], v[100:101]
    v_pk_add_f32 v[18:19], v[18:19], v[102:103]
    v_cvt_pk_bf16_f32 v16, v16, v17
    v_cvt_pk_bf16_f32 v17, v18, v19
    buffer_store_dwordx2 v[16:17], v4, s[36:39], s55 offen offset:0
    s_waitcnt lgkmcnt(9)
    v_pk_add_f32 v[20:21], v[20:21], v[108:109]
    v_pk_add_f32 v[112:113], v[112:113], v[116:117]
    v_pk_add_f32 v[22:23], v[22:23], v[110:111]
    v_pk_add_f32 v[114:115], v[114:115], v[118:119]
    v_pk_add_f32 v[20:21], v[20:21], v[112:113]
    v_pk_add_f32 v[22:23], v[22:23], v[114:115]
    v_cvt_pk_bf16_f32 v20, v20, v21
    v_cvt_pk_bf16_f32 v21, v22, v23
    buffer_store_dwordx2 v[20:21], v4, s[36:39], s55 offen offset:32
    s_waitcnt lgkmcnt(6)
    v_pk_add_f32 v[24:25], v[24:25], v[120:121]
    v_pk_add_f32 v[124:125], v[124:125], v[128:129]
    v_pk_add_f32 v[26:27], v[26:27], v[122:123]
    v_pk_add_f32 v[126:127], v[126:127], v[130:131]
    v_pk_add_f32 v[24:25], v[24:25], v[124:125]
    v_pk_add_f32 v[26:27], v[26:27], v[126:127]
    v_cvt_pk_bf16_f32 v24, v24, v25
    v_cvt_pk_bf16_f32 v25, v26, v27
    buffer_store_dwordx2 v[24:25], v4, s[36:39], s55 offen offset:64
    s_waitcnt lgkmcnt(3)
    v_pk_add_f32 v[28:29], v[28:29], v[132:133]
    v_pk_add_f32 v[136:137], v[136:137], v[140:141]
    v_pk_add_f32 v[30:31], v[30:31], v[134:135]
    v_pk_add_f32 v[138:139], v[138:139], v[142:143]
    v_pk_add_f32 v[28:29], v[28:29], v[136:137]
    v_pk_add_f32 v[30:31], v[30:31], v[138:139]
    v_cvt_pk_bf16_f32 v28, v28, v29
    v_cvt_pk_bf16_f32 v29, v30, v31
    buffer_store_dwordx2 v[28:29], v4, s[36:39], s55 offen offset:96
    s_waitcnt lgkmcnt(0)
    v_pk_add_f32 v[32:33], v[32:33], v[144:145]
    v_pk_add_f32 v[148:149], v[148:149], v[152:153]
    v_pk_add_f32 v[34:35], v[34:35], v[146:147]
    v_pk_add_f32 v[150:151], v[150:151], v[154:155]
    v_pk_add_f32 v[32:33], v[32:33], v[148:149]
    v_pk_add_f32 v[34:35], v[34:35], v[150:151]
    v_cvt_pk_bf16_f32 v32, v32, v33
    v_cvt_pk_bf16_f32 v33, v34, v35
    buffer_store_dwordx2 v[32:33], v4, s[36:39], s55 offen offset:128
    s_branch K3_end
K3_red1:
    s_cmp_lg_u32 s48, 1
    s_cbranch_scc1 K3_red2
    ds_write_b128 v3, v[16:19] offset:0
    ds_write_b128 v3, v[20:23] offset:1024
    ds_write_b128 v3, v[24:27] offset:2048
    ds_write_b128 v3, v[28:31] offset:3072
    ds_write_b128 v3, v[32:35] offset:4096
    ds_write_b128 v3, v[56:59] offset:10240
    ds_write_b128 v3, v[60:63] offset:11264
    ds_write_b128 v3, v[64:67] offset:12288
    ds_write_b128 v3, v[68:71] offset:13312
    ds_write_b128 v3, v[72:75] offset:14336
    ds_write_b128 v3, v[76:79] offset:15360
    ds_write_b128 v3, v[80:83] offset:16384
    ds_write_b128 v3, v[84:87] offset:17408
    ds_write_b128 v3, v[88:91] offset:18432
    ds_write_b128 v3, v[92:95] offset:19456
    s_waitcnt lgkmcnt(0)
    s_barrier
    v_add_u32 v5, 5120, v10
    v_add_u32 v6, 87040, v10
    v_add_u32 v7, 128000, v10
    ds_read_b128 v[96:99], v5 offset:0
    ds_read_b128 v[100:103], v6 offset:0
    ds_read_b128 v[104:107], v7 offset:0
    ds_read_b128 v[108:111], v5 offset:1024
    ds_read_b128 v[112:115], v6 offset:1024
    ds_read_b128 v[116:119], v7 offset:1024
    ds_read_b128 v[120:123], v5 offset:2048
    ds_read_b128 v[124:127], v6 offset:2048
    ds_read_b128 v[128:131], v7 offset:2048
    ds_read_b128 v[132:135], v5 offset:3072
    ds_read_b128 v[136:139], v6 offset:3072
    ds_read_b128 v[140:143], v7 offset:3072
    ds_read_b128 v[144:147], v5 offset:4096
    ds_read_b128 v[148:151], v6 offset:4096
    ds_read_b128 v[152:155], v7 offset:4096
    s_waitcnt lgkmcnt(12)
    v_pk_add_f32 v[36:37], v[36:37], v[96:97]
    v_pk_add_f32 v[100:101], v[100:101], v[104:105]
    v_pk_add_f32 v[38:39], v[38:39], v[98:99]
    v_pk_add_f32 v[102:103], v[102:103], v[106:107]
    v_pk_add_f32 v[36:37], v[36:37], v[100:101]
    v_pk_add_f32 v[38:39], v[38:39], v[102:103]
    v_cvt_pk_bf16_f32 v36, v36, v37
    v_cvt_pk_bf16_f32 v37, v38, v39
    buffer_store_dwordx2 v[36:37], v4, s[36:39], s55 offen offset:0
    s_waitcnt lgkmcnt(9)
    v_pk_add_f32 v[40:41], v[40:41], v[108:109]
    v_pk_add_f32 v[112:113], v[112:113], v[116:117]
    v_pk_add_f32 v[42:43], v[42:43], v[110:111]
    v_pk_add_f32 v[114:115], v[114:115], v[118:119]
    v_pk_add_f32 v[40:41], v[40:41], v[112:113]
    v_pk_add_f32 v[42:43], v[42:43], v[114:115]
    v_cvt_pk_bf16_f32 v40, v40, v41
    v_cvt_pk_bf16_f32 v41, v42, v43
    buffer_store_dwordx2 v[40:41], v4, s[36:39], s55 offen offset:32
    s_waitcnt lgkmcnt(6)
    v_pk_add_f32 v[44:45], v[44:45], v[120:121]
    v_pk_add_f32 v[124:125], v[124:125], v[128:129]
    v_pk_add_f32 v[46:47], v[46:47], v[122:123]
    v_pk_add_f32 v[126:127], v[126:127], v[130:131]
    v_pk_add_f32 v[44:45], v[44:45], v[124:125]
    v_pk_add_f32 v[46:47], v[46:47], v[126:127]
    v_cvt_pk_bf16_f32 v44, v44, v45
    v_cvt_pk_bf16_f32 v45, v46, v47
    buffer_store_dwordx2 v[44:45], v4, s[36:39], s55 offen offset:64
    s_waitcnt lgkmcnt(3)
    v_pk_add_f32 v[48:49], v[48:49], v[132:133]
    v_pk_add_f32 v[136:137], v[136:137], v[140:141]
    v_pk_add_f32 v[50:51], v[50:51], v[134:135]
    v_pk_add_f32 v[138:139], v[138:139], v[142:143]
    v_pk_add_f32 v[48:49], v[48:49], v[136:137]
    v_pk_add_f32 v[50:51], v[50:51], v[138:139]
    v_cvt_pk_bf16_f32 v48, v48, v49
    v_cvt_pk_bf16_f32 v49, v50, v51
    buffer_store_dwordx2 v[48:49], v4, s[36:39], s55 offen offset:96
    s_waitcnt lgkmcnt(0)
    v_pk_add_f32 v[52:53], v[52:53], v[144:145]
    v_pk_add_f32 v[148:149], v[148:149], v[152:153]
    v_pk_add_f32 v[54:55], v[54:55], v[146:147]
    v_pk_add_f32 v[150:151], v[150:151], v[154:155]
    v_pk_add_f32 v[52:53], v[52:53], v[148:149]
    v_pk_add_f32 v[54:55], v[54:55], v[150:151]
    v_cvt_pk_bf16_f32 v52, v52, v53
    v_cvt_pk_bf16_f32 v53, v54, v55
    buffer_store_dwordx2 v[52:53], v4, s[36:39], s55 offen offset:128
    s_branch K3_end
K3_red2:
    s_cmp_lg_u32 s48, 2
    s_cbranch_scc1 K3_red3
    ds_write_b128 v3, v[16:19] offset:0
    ds_write_b128 v3, v[20:23] offset:1024
    ds_write_b128 v3, v[24:27] offset:2048
    ds_write_b128 v3, v[28:31] offset:3072
    ds_write_b128 v3, v[32:35] offset:4096
    ds_write_b128 v3, v[36:39] offset:5120
    ds_write_b128 v3, v[40:43] offset:6144
    ds_write_b128 v3, v[44:47] offset:7168
    ds_write_b128 v3, v[48:51] offset:8192
    ds_write_b128 v3, v[52:55] offset:9216
    ds_write_b128 v3, v[76:79] offset:15360
    ds_write_b128 v3, v[80:83] offset:16384
    ds_write_b128 v3, v[84:87] offset:17408
    ds_write_b128 v3, v[88:91] offset:18432
    ds_write_b128 v3, v[92:95] offset:19456
    s_waitcnt lgkmcnt(0)
    s_barrier
    v_add_u32 v5, 10240, v10
    v_add_u32 v6, 51200, v10
    v_add_u32 v7, 133120, v10
    ds_read_b128 v[96:99], v5 offset:0
    ds_read_b128 v[100:103], v6 offset:0
    ds_read_b128 v[104:107], v7 offset:0
    ds_read_b128 v[108:111], v5 offset:1024
    ds_read_b128 v[112:115], v6 offset:1024
    ds_read_b128 v[116:119], v7 offset:1024
    ds_read_b128 v[120:123], v5 offset:2048
    ds_read_b128 v[124:127], v6 offset:2048
    ds_read_b128 v[128:131], v7 offset:2048
    ds_read_b128 v[132:135], v5 offset:3072
    ds_read_b128 v[136:139], v6 offset:3072
    ds_read_b128 v[140:143], v7 offset:3072
    ds_read_b128 v[144:147], v5 offset:4096
    ds_read_b128 v[148:151], v6 offset:4096
    ds_read_b128 v[152:155], v7 offset:4096
    s_waitcnt lgkmcnt(12)
    v_pk_add_f32 v[56:57], v[56:57], v[96:97]
    v_pk_add_f32 v[100:101], v[100:101], v[104:105]
    v_pk_add_f32 v[58:59], v[58:59], v[98:99]
    v_pk_add_f32 v[102:103], v[102:103], v[106:107]
    v_pk_add_f32 v[56:57], v[56:57], v[100:101]
    v_pk_add_f32 v[58:59], v[58:59], v[102:103]
    v_cvt_pk_bf16_f32 v56, v56, v57
    v_cvt_pk_bf16_f32 v57, v58, v59
    buffer_store_dwordx2 v[56:57], v4, s[36:39], s55 offen offset:0
    s_waitcnt lgkmcnt(9)
    v_pk_add_f32 v[60:61], v[60:61], v[108:109]
    v_pk_add_f32 v[112:113], v[112:113], v[116:117]
    v_pk_add_f32 v[62:63], v[62:63], v[110:111]
    v_pk_add_f32 v[114:115], v[114:115], v[118:119]
    v_pk_add_f32 v[60:61], v[60:61], v[112:113]
    v_pk_add_f32 v[62:63], v[62:63], v[114:115]
    v_cvt_pk_bf16_f32 v60, v60, v61
    v_cvt_pk_bf16_f32 v61, v62, v63
    buffer_store_dwordx2 v[60:61], v4, s[36:39], s55 offen offset:32
    s_waitcnt lgkmcnt(6)
    v_pk_add_f32 v[64:65], v[64:65], v[120:121]
    v_pk_add_f32 v[124:125], v[124:125], v[128:129]
    v_pk_add_f32 v[66:67], v[66:67], v[122:123]
    v_pk_add_f32 v[126:127], v[126:127], v[130:131]
    v_pk_add_f32 v[64:65], v[64:65], v[124:125]
    v_pk_add_f32 v[66:67], v[66:67], v[126:127]
    v_cvt_pk_bf16_f32 v64, v64, v65
    v_cvt_pk_bf16_f32 v65, v66, v67
    buffer_store_dwordx2 v[64:65], v4, s[36:39], s55 offen offset:64
    s_waitcnt lgkmcnt(3)
    v_pk_add_f32 v[68:69], v[68:69], v[132:133]
    v_pk_add_f32 v[136:137], v[136:137], v[140:141]
    v_pk_add_f32 v[70:71], v[70:71], v[134:135]
    v_pk_add_f32 v[138:139], v[138:139], v[142:143]
    v_pk_add_f32 v[68:69], v[68:69], v[136:137]
    v_pk_add_f32 v[70:71], v[70:71], v[138:139]
    v_cvt_pk_bf16_f32 v68, v68, v69
    v_cvt_pk_bf16_f32 v69, v70, v71
    buffer_store_dwordx2 v[68:69], v4, s[36:39], s55 offen offset:96
    s_waitcnt lgkmcnt(0)
    v_pk_add_f32 v[72:73], v[72:73], v[144:145]
    v_pk_add_f32 v[148:149], v[148:149], v[152:153]
    v_pk_add_f32 v[74:75], v[74:75], v[146:147]
    v_pk_add_f32 v[150:151], v[150:151], v[154:155]
    v_pk_add_f32 v[72:73], v[72:73], v[148:149]
    v_pk_add_f32 v[74:75], v[74:75], v[150:151]
    v_cvt_pk_bf16_f32 v72, v72, v73
    v_cvt_pk_bf16_f32 v73, v74, v75
    buffer_store_dwordx2 v[72:73], v4, s[36:39], s55 offen offset:128
    s_branch K3_end
K3_red3:
    ds_write_b128 v3, v[16:19] offset:0
    ds_write_b128 v3, v[20:23] offset:1024
    ds_write_b128 v3, v[24:27] offset:2048
    ds_write_b128 v3, v[28:31] offset:3072
    ds_write_b128 v3, v[32:35] offset:4096
    ds_write_b128 v3, v[36:39] offset:5120
    ds_write_b128 v3, v[40:43] offset:6144
    ds_write_b128 v3, v[44:47] offset:7168
    ds_write_b128 v3, v[48:51] offset:8192
    ds_write_b128 v3, v[52:55] offset:9216
    ds_write_b128 v3, v[56:59] offset:10240
    ds_write_b128 v3, v[60:63] offset:11264
    ds_write_b128 v3, v[64:67] offset:12288
    ds_write_b128 v3, v[68:71] offset:13312
    ds_write_b128 v3, v[72:75] offset:14336
    s_waitcnt lgkmcnt(0)
    s_barrier
    v_add_u32 v5, 15360, v10
    v_add_u32 v6, 56320, v10
    v_add_u32 v7, 97280, v10
    ds_read_b128 v[96:99], v5 offset:0
    ds_read_b128 v[100:103], v6 offset:0
    ds_read_b128 v[104:107], v7 offset:0
    ds_read_b128 v[108:111], v5 offset:1024
    ds_read_b128 v[112:115], v6 offset:1024
    ds_read_b128 v[116:119], v7 offset:1024
    ds_read_b128 v[120:123], v5 offset:2048
    ds_read_b128 v[124:127], v6 offset:2048
    ds_read_b128 v[128:131], v7 offset:2048
    ds_read_b128 v[132:135], v5 offset:3072
    ds_read_b128 v[136:139], v6 offset:3072
    ds_read_b128 v[140:143], v7 offset:3072
    ds_read_b128 v[144:147], v5 offset:4096
    ds_read_b128 v[148:151], v6 offset:4096
    ds_read_b128 v[152:155], v7 offset:4096
    s_waitcnt lgkmcnt(12)
    v_pk_add_f32 v[76:77], v[76:77], v[96:97]
    v_pk_add_f32 v[100:101], v[100:101], v[104:105]
    v_pk_add_f32 v[78:79], v[78:79], v[98:99]
    v_pk_add_f32 v[102:103], v[102:103], v[106:107]
    v_pk_add_f32 v[76:77], v[76:77], v[100:101]
    v_pk_add_f32 v[78:79], v[78:79], v[102:103]
    v_cvt_pk_bf16_f32 v76, v76, v77
    v_cvt_pk_bf16_f32 v77, v78, v79
    buffer_store_dwordx2 v[76:77], v4, s[36:39], s55 offen offset:0
    s_waitcnt lgkmcnt(9)
    v_pk_add_f32 v[80:81], v[80:81], v[108:109]
    v_pk_add_f32 v[112:113], v[112:113], v[116:117]
    v_pk_add_f32 v[82:83], v[82:83], v[110:111]
    v_pk_add_f32 v[114:115], v[114:115], v[118:119]
    v_pk_add_f32 v[80:81], v[80:81], v[112:113]
    v_pk_add_f32 v[82:83], v[82:83], v[114:115]
    v_cvt_pk_bf16_f32 v80, v80, v81
    v_cvt_pk_bf16_f32 v81, v82, v83
    buffer_store_dwordx2 v[80:81], v4, s[36:39], s55 offen offset:32
    s_waitcnt lgkmcnt(6)
    v_pk_add_f32 v[84:85], v[84:85], v[120:121]
    v_pk_add_f32 v[124:125], v[124:125], v[128:129]
    v_pk_add_f32 v[86:87], v[86:87], v[122:123]
    v_pk_add_f32 v[126:127], v[126:127], v[130:131]
    v_pk_add_f32 v[84:85], v[84:85], v[124:125]
    v_pk_add_f32 v[86:87], v[86:87], v[126:127]
    v_cvt_pk_bf16_f32 v84, v84, v85
    v_cvt_pk_bf16_f32 v85, v86, v87
    buffer_store_dwordx2 v[84:85], v4, s[36:39], s55 offen offset:64
    s_waitcnt lgkmcnt(3)
    v_pk_add_f32 v[88:89], v[88:89], v[132:133]
    v_pk_add_f32 v[136:137], v[136:137], v[140:141]
    v_pk_add_f32 v[90:91], v[90:91], v[134:135]
    v_pk_add_f32 v[138:139], v[138:139], v[142:143]
    v_pk_add_f32 v[88:89], v[88:89], v[136:137]
    v_pk_add_f32 v[90:91], v[90:91], v[138:139]
    v_cvt_pk_bf16_f32 v88, v88, v89
    v_cvt_pk_bf16_f32 v89, v90, v91
    buffer_store_dwordx2 v[88:89], v4, s[36:39], s55 offen offset:96
    s_waitcnt lgkmcnt(0)
    v_pk_add_f32 v[92:93], v[92:93], v[144:145]
    v_pk_add_f32 v[148:149], v[148:149], v[152:153]
    v_pk_add_f32 v[94:95], v[94:95], v[146:147]
    v_pk_add_f32 v[150:151], v[150:151], v[154:155]
    v_pk_add_f32 v[92:93], v[92:93], v[148:149]
    v_pk_add_f32 v[94:95], v[94:95], v[150:151]
    v_cvt_pk_bf16_f32 v92, v92, v93
    v_cvt_pk_bf16_f32 v93, v94, v95
    buffer_store_dwordx2 v[92:93], v4, s[36:39], s55 offen offset:128
K3_end:
K3_done:
    s_endpgm
.section .rodata,"a"
.p2align 6
.amdhsa_kernel qkv_kernel
  .amdhsa_next_free_vgpr 248
  .amdhsa_next_free_sgpr 102
  .amdhsa_accum_offset 248
  .amdhsa_group_segment_fixed_size 0
  .amdhsa_kernarg_size 80
  .amdhsa_user_sgpr_count 2
  .amdhsa_user_sgpr_kernarg_segment_ptr 1
  .amdhsa_system_sgpr_workgroup_id_x 1
.end_amdhsa_kernel
.amdhsa_kernel attn_kernel
  .amdhsa_next_free_vgpr 144
  .amdhsa_next_free_sgpr 102
  .amdhsa_accum_offset 144
  .amdhsa_group_segment_fixed_size 0
  .amdhsa_kernarg_size 80
  .amdhsa_user_sgpr_count 2
  .amdhsa_user_sgpr_kernarg_segment_ptr 1
  .amdhsa_system_sgpr_workgroup_id_x 1
.end_amdhsa_kernel
.amdhsa_kernel oproj_kernel
  .amdhsa_next_free_vgpr 248
  .amdhsa_next_free_sgpr 102
  .amdhsa_accum_offset 248
  .amdhsa_group_segment_fixed_size 0
  .amdhsa_kernarg_size 80
  .amdhsa_user_sgpr_count 2
  .amdhsa_user_sgpr_kernarg_segment_ptr 1
  .amdhsa_system_sgpr_workgroup_id_x 1
.end_amdhsa_kernel
```
